```python
import torch

def _softmax(x, axis=-1):
    return torch.softmax(x, dim=axis)

def _gelu(x):
    return torch.nn.functional.gelu(x, approximate='tanh')

def _silu(x):
    return torch.nn.functional.silu(x)

def _sigmoid(x):
    return torch.sigmoid(x)

def _layernorm(x, axis=-1, eps=1e-05):
    m = x.mean(dim=axis, keepdim=True)
    v = x.var(dim=axis, keepdim=True, unbiased=False)
    return (x - m) / torch.sqrt(v + eps)

def _scatter_add(tgt, idx, src, axis=0):
    return tgt.clone().index_add_(axis, idx, src)

def _segment_sum(src, seg, n):
    out = torch.zeros((n,) + src.shape[1:], dtype=src.dtype)
    return out.index_add_(0, seg, src)

def _pad(x, pw):
    flat = tuple((v for pair in reversed(pw) for v in pair))
    return torch.nn.functional.pad(x, flat)
kernel_name = 'standalone__tree_speculative_verify_tree_attention_over_candidate_token_tree__decode'

def setup_inputs():

    _w = lambda a: (lambda t: t.to(torch.bfloat16) if t.is_floating_point() else t)(torch.as_tensor(a))
    B, Hq, Hkv, T, C, D = (2, 32, 32, 1, 16384, 128)
    tree_mask = torch.zeros((B, T, T), dtype=float)
    for b in range(B):
        parent = torch.zeros(T, dtype=torch.int64)
        for i in range(1, T):
            parent[i] = int(torch.randint(0, i, (1,)).item())
        for i in range(T):
            j = i
            tree_mask[b, i, j] = 1.0
            while j > 0:
                j = parent[j]
                tree_mask[b, i, j] = 1.0
    return {'q': _w((lambda *s: torch.randn(*s, dtype=torch.bfloat16) * 0.8)(B, Hq, T, D)), 'k_cache': _w((lambda *s: torch.randn(*s, dtype=torch.bfloat16) * 0.8)(B, Hkv, C, D)), 'v_cache': _w((lambda *s: torch.randn(*s, dtype=torch.bfloat16) * 0.05)(B, Hkv, C, D)), 'k_tree': _w((lambda *s: torch.randn(*s, dtype=torch.bfloat16) * 0.8)(B, Hkv, T, D)), 'v_tree': _w((lambda *s: torch.randn(*s, dtype=torch.bfloat16) * 0.05)(B, Hkv, T, D)), 'tree_mask': _w(tree_mask)}

def reference(q, k_cache, v_cache, k_tree, v_tree, tree_mask):
    B, Hq, T, D = q.shape
    Hkv, C = (k_cache.shape[1], k_cache.shape[2])
    rep = Hq // Hkv
    kc = (lambda x, n, axis: torch.repeat_interleave(x, n, dim=axis))(k_cache, rep, axis=1)
    vc = (lambda x, n, axis: torch.repeat_interleave(x, n, dim=axis))(v_cache, rep, axis=1)
    kt = (lambda x, n, axis: torch.repeat_interleave(x, n, dim=axis))(k_tree, rep, axis=1)
    vt = (lambda x, n, axis: torch.repeat_interleave(x, n, dim=axis))(v_tree, rep, axis=1)
    k = torch.concatenate([kc, kt], axis=2)
    v = torch.concatenate([vc, vt], axis=2)
    scale = D ** (-0.5)
    scores = torch.einsum('bhqd,bhkd->bhqk', q, k) * scale
    ctx_mask = torch.ones((B, 1, T, C), dtype=scores.dtype)
    tm = tree_mask[:, None, :, :].clone()
    full_mask = torch.concatenate([ctx_mask, tm], axis=-1)
    scores = scores + (1.0 - full_mask) * -1000000000.0
    p = _softmax(scores, axis=-1)
    return torch.einsum('bhqk,bhkd->bhqd', p, v)
```

```asm
; @launch grid=(256,1,1) block=(64,1,1) lds=16576
.amdgcn_target "amdgcn-amd-amdhsa--gfx950"
.text
.globl standalone__tree_speculative_verify_tree_attention_over_candidate_token_tree__decode_kernel
.p2align 8
.type standalone__tree_speculative_verify_tree_attention_over_candidate_token_tree__decode_kernel,@function
standalone__tree_speculative_verify_tree_attention_over_candidate_token_tree__decode_kernel:
    s_load_dwordx16 s[24:39], s[0:1], 0
    s_load_dwordx2 s[40:41], s[0:1], 64
    s_cmp_ge_u32 s2, 256
    s_cbranch_scc1 L_end
    s_lshr_b32 s49, s2, 3
    s_getpc_b64 s[46:47]
L_pc:
    s_mul_i32 s12, s49, 512
    v_mad_u32_u24 v75, v0, 8, s12
    global_load_dword v48, v75, s[46:47] offset:128
    s_bfe_u32 s19, s2, 0x10000
    s_lshl_b32 s19, s19, 5
    s_bfe_u32 s42, s2, 0x20001
    s_xor_b32 s19, s19, s42
    s_bfe_u32 s42, s2, 0x30005
    s_lshl_b32 s42, s42, 2
    s_xor_b32 s19, s19, s42
    s_bfe_u32 s15, s2, 0x10003
    s_lshl_b32 s15, s15, 8
    s_bfe_u32 s42, s2, 0x10004
    s_lshl_b32 s42, s42, 16
    s_xor_b32 s15, s15, s42
    s_bfe_u32 s14, s2, 0x10006
    s_lshl_b32 s14, s14, 14
    v_lshrrev_b32 v5, 4, v0
    v_lshlrev_b32 v5, 6, v5
    v_and_b32 v6, 3, v0
    v_lshl_add_u32 v5, v6, 4, v5
    v_bfe_u32 v6, v0, 2, 1
    v_lshl_add_u32 v1, v6, 11, v5
    v_bfe_u32 v6, v0, 3, 1
    v_lshl_add_u32 v1, v6, 21, v1
    v_add_u32 v1, s15, v1
    s_lshl_b32 s42, s19, 22
    s_mov_b32 s16, s14
    s_mov_b32 s10, 0x400000
    s_mov_b32 s11, 0x20000
    s_mov_b32 s68, 0x8000
    s_mov_b32 s69, 0x9000
    s_mov_b32 s70, 0xb000
    s_mov_b32 s71, 0xf000
    s_bfe_u32 s20, s2, 0x20003
    s_lshl_b32 s43, s20, 10
    s_lshl_b32 s44, s19, 8
    s_lshl_b32 s45, s19, 12
    v_lshlrev_b32 v73, 2, v0
    v_lshlrev_b32 v52, 4, v0
    v_and_b32 v2, 0xf0, v52
    v_bfe_u32 v7, v0, 4, 1
    v_lshl_add_u32 v53, v7, 3, v2
    v_add_u32 v52, s43, v52
    s_waitcnt lgkmcnt(0)
    s_add_u32 s8, s26, s42
    s_addc_u32 s9, s27, 0
    buffer_load_dwordx4 v[88:91], v1, s[8:11], s16 offen offset:0 nt
    s_xor_b32 s16, s16, s68
    s_load_dword s58, s[24:25], 0
    s_load_dword s59, s[40:41], 0
    s_load_dword s60, s[30:31], 0
    s_load_dword s61, s[32:33], 0
    buffer_load_dwordx4 v[92:95], v1, s[8:11], s16 offen offset:0 nt
    s_xor_b32 s16, s16, s69
    buffer_load_dwordx4 v[96:99], v1, s[8:11], s16 offen offset:0 nt
    s_xor_b32 s16, s16, s68
    buffer_load_dwordx4 v[100:103], v1, s[8:11], s16 offen offset:0 nt
    s_xor_b32 s16, s16, s70
    s_add_u32 s24, s24, s44
    s_addc_u32 s25, s25, 0
    global_load_dwordx4 v[16:19], v5, s[24:25]
    s_load_dword s48, s[34:35], 0
    s_getreg_b32 s22, hwreg(HW_REG_XCC_ID, 0, 3)
    s_mul_i32 s12, s22, 4352
    s_add_u32 s12, s12, 0x40000
    s_add_u32 s64, s40, s12
    s_addc_u32 s65, s41, 0
    s_add_u32 s40, s40, s45
    s_addc_u32 s41, s41, 0
    global_load_dword v74, v73, s[64:65] sc1
    s_add_u32 s30, s30, s44
    s_addc_u32 s31, s31, 0
    s_add_u32 s32, s32, s44
    s_addc_u32 s33, s33, 0
    global_load_dword v24, v73, s[24:25]
    global_load_dword v25, v73, s[30:31]
    global_load_dwordx2 v[86:87], v53, s[32:33]
    v_xor_b32 v3, 0x400, v52
    global_load_dwordx4 v[56:59], v3, s[40:41] sc1
    v_xor_b32 v50, 0x800, v52
    global_load_dwordx4 v[60:63], v50, s[40:41] sc1
    v_xor_b32 v51, 0xc00, v52
    global_load_dwordx4 v[64:67], v51, s[40:41] sc1
    global_load_dwordx4 v[68:71], v52, s[40:41] sc1
    buffer_load_dwordx4 v[104:107], v1, s[8:11], s16 offen offset:0 nt
    s_xor_b32 s16, s16, s68
    buffer_load_dwordx4 v[108:111], v1, s[8:11], s16 offen offset:0 nt
    s_xor_b32 s16, s16, s69
    buffer_load_dwordx4 v[112:115], v1, s[8:11], s16 offen offset:0 nt
    s_xor_b32 s16, s16, s68
    buffer_load_dwordx4 v[116:119], v1, s[8:11], s16 offen offset:0 nt
    s_xor_b32 s16, s16, s71
    buffer_load_dwordx4 v[120:123], v1, s[8:11], s16 offen offset:0 nt
    s_xor_b32 s16, s16, s68
    s_mov_b32 s17, 1
    s_xor_b32 s13, s14, 0x20000
    buffer_load_dwordx4 v[124:127], v1, s[8:11], s16 offen offset:0 nt
    s_xor_b32 s16, s16, s69
    buffer_load_dwordx4 v[128:131], v1, s[8:11], s16 offen offset:0 nt
    s_xor_b32 s16, s16, s68
    buffer_load_dwordx4 v[132:135], v1, s[8:11], s16 offen offset:0 nt
    s_xor_b32 s16, s16, s70
    buffer_load_dwordx4 v[136:139], v1, s[8:11], s16 offen offset:0 nt
    s_xor_b32 s16, s16, s68
    buffer_load_dwordx4 v[140:143], v1, s[8:11], s16 offen offset:0 nt
    s_xor_b32 s16, s16, s69
    buffer_load_dwordx4 v[144:147], v1, s[8:11], s16 offen offset:0 nt
    s_xor_b32 s16, s16, s68
    buffer_load_dwordx4 v[148:151], v1, s[8:11], s16 offen offset:0 nt
    s_xor_b32 s16, s16, s71
    buffer_load_dwordx4 v[152:155], v1, s[8:11], s16 offen offset:1024 nt
    s_xor_b32 s16, s16, s68
    buffer_load_dwordx4 v[156:159], v1, s[8:11], s16 offen offset:1024 nt
    s_xor_b32 s16, s16, s69
    buffer_load_dwordx4 v[160:163], v1, s[8:11], s16 offen offset:1024 nt
    s_xor_b32 s16, s16, s68
    buffer_load_dwordx4 v[164:167], v1, s[8:11], s16 offen offset:1024 nt
    s_xor_b32 s16, s16, s70
    buffer_load_dwordx4 v[168:171], v1, s[8:11], s16 offen offset:1024 nt
    s_xor_b32 s16, s16, s68
    buffer_load_dwordx4 v[172:175], v1, s[8:11], s16 offen offset:1024 nt
    s_xor_b32 s16, s16, s69
    buffer_load_dwordx4 v[176:179], v1, s[8:11], s16 offen offset:1024 nt
    s_xor_b32 s16, s16, s68
    buffer_load_dwordx4 v[180:183], v1, s[8:11], s16 offen offset:1024 nt
    s_xor_b32 s16, s16, s71
    buffer_load_dwordx4 v[184:187], v1, s[8:11], s16 offen offset:1024 nt
    s_xor_b32 s16, s16, s68
    buffer_load_dwordx4 v[188:191], v1, s[8:11], s16 offen offset:1024 nt
    s_xor_b32 s16, s16, s69
    buffer_load_dwordx4 v[192:195], v1, s[8:11], s16 offen offset:1024 nt
    s_xor_b32 s16, s16, s68
    buffer_load_dwordx4 v[196:199], v1, s[8:11], s16 offen offset:1024 nt
    s_xor_b32 s16, s16, s70
    v_mov_b32 v10, 0xff800000
    v_and_b32 v72, 60, v0
    v_mov_b32 v20, v10
    v_mov_b32 v21, v10
    v_mov_b32 v22, v10
    v_mov_b32 v23, v10
    s_bitcmp1_b32 s22, 0
    s_cselect_b32 s50, 0, 9
    s_mul_i32 s42, s49, 13
    s_add_u32 s42, s42, 5
    s_and_b32 s42, s42, 31
    s_lshl_b64 s[4:5], 1, s42
    s_add_u32 s3, s42, 0
    s_add_u32 s6, s42, 0
    s_and_b32 s49, s49, 15
    s_mov_b32 s21, 0
    s_mov_b32 s66, 2
    s_waitcnt vmcnt(36)
    buffer_load_dwordx4 v[200:203], v1, s[8:11], s16 offen offset:1024 nt
    s_xor_b32 s16, s16, s68
    s_waitcnt vmcnt(36)
    buffer_load_dwordx4 v[204:207], v1, s[8:11], s16 offen offset:1024 nt
    s_xor_b32 s16, s16, s69
    s_waitcnt vmcnt(36)
    buffer_load_dwordx4 v[208:211], v1, s[8:11], s16 offen offset:1024 nt
    s_xor_b32 s16, s16, s68
    s_waitcnt vmcnt(36)
    buffer_load_dwordx4 v[212:215], v1, s[8:11], s16 offen offset:1024 nt
    s_mov_b32 s16, s13
    v_bfe_u32 v6, v0, 2, 2
    v_cmp_eq_u32 s[42:43], 0, v6
    v_cmp_eq_u32 s[44:45], 2, v6
    v_cmp_eq_u32 s[46:47], 1, v6
    v_cmp_eq_u32 s[34:35], 3, v6
    s_waitcnt vmcnt(36)
    v_cndmask_b32 v32, 0, v16, s[42:43]
    v_cndmask_b32 v33, 0, v17, s[42:43]
    v_cndmask_b32 v34, 0, v18, s[42:43]
    v_cndmask_b32 v35, 0, v19, s[42:43]
    v_cndmask_b32 v36, 0, v16, s[44:45]
    v_cndmask_b32 v37, 0, v17, s[44:45]
    v_cndmask_b32 v38, 0, v18, s[44:45]
    v_cndmask_b32 v39, 0, v19, s[44:45]
    v_cndmask_b32 v40, 0, v16, s[46:47]
    v_cndmask_b32 v41, 0, v17, s[46:47]
    v_cndmask_b32 v42, 0, v18, s[46:47]
    v_cndmask_b32 v43, 0, v19, s[46:47]
    v_cndmask_b32 v44, 0, v16, s[34:35]
    v_cndmask_b32 v45, 0, v17, s[34:35]
    v_cndmask_b32 v46, 0, v18, s[34:35]
    v_cndmask_b32 v47, 0, v19, s[34:35]
    s_waitcnt vmcnt(35)
    v_not_b32 v75, v74
L_k1:
    v_mfma_f32_16x16x32_bf16 v[16:19], v[88:91], v[32:35], 0
    s_waitcnt vmcnt(20)
    buffer_load_dwordx4 v[88:91], v1, s[8:11], s16 offen offset:0 nt
    s_xor_b32 s16, s16, s68
    v_mfma_f32_16x16x32_bf16 v[16:19], v[92:95], v[36:39], v[16:19]
    s_waitcnt vmcnt(20)
    buffer_load_dwordx4 v[92:95], v1, s[8:11], s16 offen offset:0 nt
    s_xor_b32 s16, s16, s69
    v_mov_b32_dpp v5, v20 quad_perm:[0,0,0,0] row_mask:0xf bank_mask:0xf
    v_mov_b32_dpp v6, v22 quad_perm:[2,2,2,2] row_mask:0xf bank_mask:0xf
    v_mfma_f32_16x16x32_bf16 v[16:19], v[96:99], v[40:43], v[16:19]
    s_waitcnt vmcnt(20)
    buffer_load_dwordx4 v[96:99], v1, s[8:11], s16 offen offset:0 nt
    s_xor_b32 s16, s16, s68
    v_add_f32_dpp v5, v21, v5 quad_perm:[1,1,1,1] row_mask:0xf bank_mask:0xf
    v_add_f32_dpp v6, v23, v6 quad_perm:[3,3,3,3] row_mask:0xf bank_mask:0xf
    v_add_f32 v5, v5, v6
    v_max_f32 v10, v10, v5
    ds_write_b32 v72, v5 offset:0
    v_mfma_f32_16x16x32_bf16 v[16:19], v[100:103], v[44:47], v[16:19]
    s_waitcnt vmcnt(20)
    buffer_load_dwordx4 v[100:103], v1, s[8:11], s16 offen offset:0 nt
    s_xor_b32 s16, s16, s70
    v_mfma_f32_16x16x32_bf16 v[20:23], v[104:107], v[32:35], 0
    s_waitcnt vmcnt(20)
    buffer_load_dwordx4 v[104:107], v1, s[8:11], s16 offen offset:0 nt
    s_xor_b32 s16, s16, s68
    v_mfma_f32_16x16x32_bf16 v[20:23], v[108:111], v[36:39], v[20:23]
    s_waitcnt vmcnt(20)
    buffer_load_dwordx4 v[108:111], v1, s[8:11], s16 offen offset:0 nt
    s_xor_b32 s16, s16, s69
    s_cmp_eq_u32 s21, s3
    s_cbranch_scc1 L_pub_k1_0
L_pubx_k1_0:
    global_load_dword v54, v73, s[64:65] sc1
    v_mov_b32_dpp v5, v16 quad_perm:[0,0,0,0] row_mask:0xf bank_mask:0xf
    v_mov_b32_dpp v6, v18 quad_perm:[2,2,2,2] row_mask:0xf bank_mask:0xf
    v_mfma_f32_16x16x32_bf16 v[20:23], v[112:115], v[40:43], v[20:23]
    s_waitcnt vmcnt(21)
    buffer_load_dwordx4 v[112:115], v1, s[8:11], s16 offen offset:0 nt
    s_xor_b32 s16, s16, s68
    v_add_f32_dpp v5, v17, v5 quad_perm:[1,1,1,1] row_mask:0xf bank_mask:0xf
    v_add_f32_dpp v6, v19, v6 quad_perm:[3,3,3,3] row_mask:0xf bank_mask:0xf
    v_add_f32 v5, v5, v6
    v_max_f32 v10, v10, v5
    ds_write_b32 v72, v5 offset:64
    v_mfma_f32_16x16x32_bf16 v[20:23], v[116:119], v[44:47], v[20:23]
    s_waitcnt vmcnt(21)
    buffer_load_dwordx4 v[116:119], v1, s[8:11], s16 offen offset:0 nt
    s_xor_b32 s16, s16, s71
    v_mfma_f32_16x16x32_bf16 v[16:19], v[120:123], v[32:35], 0
    s_waitcnt vmcnt(21)
    buffer_load_dwordx4 v[120:123], v1, s[8:11], s16 offen offset:0 nt
    s_xor_b32 s16, s16, s68
    s_add_u32 s17, s17, 1
    s_bfe_u32 s12, s17, 0x10000
    s_lshl_b32 s12, s12, 17
    s_xor_b32 s13, s14, s12
    v_mfma_f32_16x16x32_bf16 v[16:19], v[124:127], v[36:39], v[16:19]
    s_waitcnt vmcnt(21)
    buffer_load_dwordx4 v[124:127], v1, s[8:11], s16 offen offset:0 nt
    s_xor_b32 s16, s16, s69
    s_bfe_u32 s12, s17, 0x10001
    s_lshl_b32 s12, s12, 9
    s_xor_b32 s13, s13, s12
    v_mov_b32_dpp v5, v20 quad_perm:[0,0,0,0] row_mask:0xf bank_mask:0xf
    v_mov_b32_dpp v6, v22 quad_perm:[2,2,2,2] row_mask:0xf bank_mask:0xf
    v_mfma_f32_16x16x32_bf16 v[16:19], v[128:131], v[40:43], v[16:19]
    s_waitcnt vmcnt(21)
    buffer_load_dwordx4 v[128:131], v1, s[8:11], s16 offen offset:0 nt
    s_xor_b32 s16, s16, s68
    s_bfe_u32 s12, s17, 0x30002
    s_lshl_b32 s12, s12, 18
    s_xor_b32 s13, s13, s12
    v_add_f32_dpp v5, v21, v5 quad_perm:[1,1,1,1] row_mask:0xf bank_mask:0xf
    v_add_f32_dpp v6, v23, v6 quad_perm:[3,3,3,3] row_mask:0xf bank_mask:0xf
    v_add_f32 v5, v5, v6
    v_max_f32 v10, v10, v5
    ds_write_b32 v72, v5 offset:128
    v_mfma_f32_16x16x32_bf16 v[16:19], v[132:135], v[44:47], v[16:19]
    s_waitcnt vmcnt(21)
    buffer_load_dwordx4 v[132:135], v1, s[8:11], s16 offen offset:0 nt
    s_xor_b32 s16, s16, s70
    v_mfma_f32_16x16x32_bf16 v[20:23], v[136:139], v[32:35], 0
    s_waitcnt vmcnt(21)
    buffer_load_dwordx4 v[136:139], v1, s[8:11], s16 offen offset:0 nt
    s_xor_b32 s16, s16, s68
    v_mfma_f32_16x16x32_bf16 v[20:23], v[140:143], v[36:39], v[20:23]
    s_waitcnt vmcnt(21)
    buffer_load_dwordx4 v[140:143], v1, s[8:11], s16 offen offset:0 nt
    s_xor_b32 s16, s16, s69
    v_mov_b32_dpp v5, v16 quad_perm:[0,0,0,0] row_mask:0xf bank_mask:0xf
    v_mov_b32_dpp v6, v18 quad_perm:[2,2,2,2] row_mask:0xf bank_mask:0xf
    v_mfma_f32_16x16x32_bf16 v[20:23], v[144:147], v[40:43], v[20:23]
    s_waitcnt vmcnt(21)
    buffer_load_dwordx4 v[144:147], v1, s[8:11], s16 offen offset:0 nt
    s_xor_b32 s16, s16, s68
    v_add_f32_dpp v5, v17, v5 quad_perm:[1,1,1,1] row_mask:0xf bank_mask:0xf
    v_add_f32_dpp v6, v19, v6 quad_perm:[3,3,3,3] row_mask:0xf bank_mask:0xf
    v_add_f32 v5, v5, v6
    v_max_f32 v10, v10, v5
    ds_write_b32 v72, v5 offset:192
    v_mfma_f32_16x16x32_bf16 v[20:23], v[148:151], v[44:47], v[20:23]
    s_waitcnt vmcnt(21)
    buffer_load_dwordx4 v[148:151], v1, s[8:11], s16 offen offset:0 nt
    s_xor_b32 s16, s16, s71
    v_mfma_f32_16x16x32_bf16 v[16:19], v[152:155], v[32:35], 0
    s_waitcnt vmcnt(21)
    buffer_load_dwordx4 v[152:155], v1, s[8:11], s16 offen offset:1024 nt
    s_xor_b32 s16, s16, s68
    v_mfma_f32_16x16x32_bf16 v[16:19], v[156:159], v[36:39], v[16:19]
    s_waitcnt vmcnt(21)
    buffer_load_dwordx4 v[156:159], v1, s[8:11], s16 offen offset:1024 nt
    s_xor_b32 s16, s16, s69
    v_mov_b32_dpp v5, v20 quad_perm:[0,0,0,0] row_mask:0xf bank_mask:0xf
    v_mov_b32_dpp v6, v22 quad_perm:[2,2,2,2] row_mask:0xf bank_mask:0xf
    v_mfma_f32_16x16x32_bf16 v[16:19], v[160:163], v[40:43], v[16:19]
    s_waitcnt vmcnt(21)
    buffer_load_dwordx4 v[160:163], v1, s[8:11], s16 offen offset:1024 nt
    s_xor_b32 s16, s16, s68
    v_add_f32_dpp v5, v21, v5 quad_perm:[1,1,1,1] row_mask:0xf bank_mask:0xf
    v_add_f32_dpp v6, v23, v6 quad_perm:[3,3,3,3] row_mask:0xf bank_mask:0xf
    v_add_f32 v5, v5, v6
    v_max_f32 v10, v10, v5
    ds_write_b32 v72, v5 offset:256
    v_mfma_f32_16x16x32_bf16 v[16:19], v[164:167], v[44:47], v[16:19]
    s_waitcnt vmcnt(21)
    buffer_load_dwordx4 v[164:167], v1, s[8:11], s16 offen offset:1024 nt
    s_xor_b32 s16, s16, s70
    v_mfma_f32_16x16x32_bf16 v[20:23], v[168:171], v[32:35], 0
    s_waitcnt vmcnt(21)
    buffer_load_dwordx4 v[168:171], v1, s[8:11], s16 offen offset:1024 nt
    s_xor_b32 s16, s16, s68
    v_mfma_f32_16x16x32_bf16 v[20:23], v[172:175], v[36:39], v[20:23]
    s_waitcnt vmcnt(21)
    buffer_load_dwordx4 v[172:175], v1, s[8:11], s16 offen offset:1024 nt
    s_xor_b32 s16, s16, s69
    v_mov_b32_dpp v5, v16 quad_perm:[0,0,0,0] row_mask:0xf bank_mask:0xf
    v_mov_b32_dpp v6, v18 quad_perm:[2,2,2,2] row_mask:0xf bank_mask:0xf
    v_mfma_f32_16x16x32_bf16 v[20:23], v[176:179], v[40:43], v[20:23]
    s_waitcnt vmcnt(21)
    buffer_load_dwordx4 v[176:179], v1, s[8:11], s16 offen offset:1024 nt
    s_xor_b32 s16, s16, s68
    v_add_f32_dpp v5, v17, v5 quad_perm:[1,1,1,1] row_mask:0xf bank_mask:0xf
    v_add_f32_dpp v6, v19, v6 quad_perm:[3,3,3,3] row_mask:0xf bank_mask:0xf
    v_add_f32 v5, v5, v6
    v_max_f32 v10, v10, v5
    ds_write_b32 v72, v5 offset:320
    v_mfma_f32_16x16x32_bf16 v[20:23], v[180:183], v[44:47], v[20:23]
    s_waitcnt vmcnt(21)
    buffer_load_dwordx4 v[180:183], v1, s[8:11], s16 offen offset:1024 nt
    s_xor_b32 s16, s16, s71
    v_mfma_f32_16x16x32_bf16 v[16:19], v[184:187], v[32:35], 0
    s_waitcnt vmcnt(21)
    buffer_load_dwordx4 v[184:187], v1, s[8:11], s16 offen offset:1024 nt
    s_xor_b32 s16, s16, s68
    v_mfma_f32_16x16x32_bf16 v[16:19], v[188:191], v[36:39], v[16:19]
    s_waitcnt vmcnt(21)
    buffer_load_dwordx4 v[188:191], v1, s[8:11], s16 offen offset:1024 nt
    s_xor_b32 s16, s16, s69
    s_cmp_eq_u32 s21, s6
    s_cbranch_scc1 L_pub_k1_1
L_pubx_k1_1:
    v_mov_b32_dpp v5, v20 quad_perm:[0,0,0,0] row_mask:0xf bank_mask:0xf
    v_mov_b32_dpp v6, v22 quad_perm:[2,2,2,2] row_mask:0xf bank_mask:0xf
    v_mfma_f32_16x16x32_bf16 v[16:19], v[192:195], v[40:43], v[16:19]
    s_waitcnt vmcnt(20)
    buffer_load_dwordx4 v[192:195], v1, s[8:11], s16 offen offset:1024 nt
    s_xor_b32 s16, s16, s68
    v_add_f32_dpp v5, v21, v5 quad_perm:[1,1,1,1] row_mask:0xf bank_mask:0xf
    v_add_f32_dpp v6, v23, v6 quad_perm:[3,3,3,3] row_mask:0xf bank_mask:0xf
    v_add_f32 v5, v5, v6
    v_max_f32 v10, v10, v5
    ds_write_b32 v72, v5 offset:384
    v_mfma_f32_16x16x32_bf16 v[16:19], v[196:199], v[44:47], v[16:19]
    s_waitcnt vmcnt(20)
    buffer_load_dwordx4 v[196:199], v1, s[8:11], s16 offen offset:1024 nt
    s_xor_b32 s16, s16, s70
    v_readlane_b32 s42, v74, s21
    s_add_u32 s49, s49, s50
    s_lshr_b32 s22, s49, 4
    s_and_b32 s49, s49, 15
    v_mfma_f32_16x16x32_bf16 v[20:23], v[200:203], v[32:35], 0
    s_waitcnt vmcnt(20)
    buffer_load_dwordx4 v[200:203], v1, s[8:11], s16 offen offset:1024 nt
    s_xor_b32 s16, s16, s68
    v_mfma_f32_16x16x32_bf16 v[20:23], v[204:207], v[36:39], v[20:23]
    s_waitcnt vmcnt(20)
    buffer_load_dwordx4 v[204:207], v1, s[8:11], s16 offen offset:1024 nt
    s_xor_b32 s16, s16, s69
    v_readlane_b32 s23, v54, s21
    v_mov_b32_dpp v5, v16 quad_perm:[0,0,0,0] row_mask:0xf bank_mask:0xf
    v_mov_b32_dpp v6, v18 quad_perm:[2,2,2,2] row_mask:0xf bank_mask:0xf
    v_mfma_f32_16x16x32_bf16 v[20:23], v[208:211], v[40:43], v[20:23]
    s_waitcnt vmcnt(20)
    buffer_load_dwordx4 v[208:211], v1, s[8:11], s16 offen offset:1024 nt
    s_xor_b32 s16, s16, s68
    s_xor_b32 s42, s42, s23
    s_bcnt1_i32_b32 s42, s42
    s_lshr_b32 s42, 0x90100, s42
    s_and_b32 s42, s42, 15
    s_add_u32 s22, s22, s42
    v_add_f32_dpp v5, v17, v5 quad_perm:[1,1,1,1] row_mask:0xf bank_mask:0xf
    v_add_f32_dpp v6, v19, v6 quad_perm:[3,3,3,3] row_mask:0xf bank_mask:0xf
    v_add_f32 v5, v5, v6
    v_max_f32 v10, v10, v5
    ds_write_b32 v72, v5 offset:448
    v_mfma_f32_16x16x32_bf16 v[20:23], v[212:215], v[44:47], v[20:23]
    s_waitcnt vmcnt(20)
    buffer_load_dwordx4 v[212:215], v1, s[8:11], s16 offen offset:1024 nt
    s_mov_b32 s16, s13
    v_add_u32 v72, 512, v72
    s_add_u32 s21, s21, 1
    s_cmp_eq_u32 s21, s66
    s_cbranch_scc1 L_kev
    s_cmp_eq_u32 s22, 1
    s_cbranch_scc1 L_k1
    s_cmp_eq_u32 s22, 2
    s_cbranch_scc1 L_k2
    s_cmp_eq_u32 s22, 0
    s_cbranch_scc1 L_k0
    s_branch L_k3
L_pub_k1_0:
    s_mov_b64 exec, s[4:5]
    global_store_byte v73, v75, s[64:65]
    s_mov_b64 exec, -1
    s_add_u32 s3, s3, 32
    s_branch L_pubx_k1_0
L_pub_k1_1:
    s_mov_b64 exec, s[4:5]
    global_store_short v73, v75, s[64:65]
    s_mov_b64 exec, -1
    s_add_u32 s6, s6, 32
    s_lshl_b64 s[4:5], s[4:5], 32
    s_branch L_pubx_k1_1
L_k0:
    v_mfma_f32_16x16x32_bf16 v[16:19], v[88:91], v[32:35], 0
    s_waitcnt vmcnt(19)
    buffer_load_dwordx4 v[88:91], v1, s[8:11], s16 offen offset:0 nt
    s_xor_b32 s16, s16, s68
    v_mfma_f32_16x16x32_bf16 v[16:19], v[92:95], v[36:39], v[16:19]
    s_waitcnt vmcnt(19)
    buffer_load_dwordx4 v[92:95], v1, s[8:11], s16 offen offset:0 nt
    s_xor_b32 s16, s16, s69
    v_mov_b32_dpp v5, v20 quad_perm:[0,0,0,0] row_mask:0xf bank_mask:0xf
    v_mov_b32_dpp v6, v22 quad_perm:[2,2,2,2] row_mask:0xf bank_mask:0xf
    v_mfma_f32_16x16x32_bf16 v[16:19], v[96:99], v[40:43], v[16:19]
    s_waitcnt vmcnt(19)
    buffer_load_dwordx4 v[96:99], v1, s[8:11], s16 offen offset:0 nt
    s_xor_b32 s16, s16, s68
    v_add_f32_dpp v5, v21, v5 quad_perm:[1,1,1,1] row_mask:0xf bank_mask:0xf
    v_add_f32_dpp v6, v23, v6 quad_perm:[3,3,3,3] row_mask:0xf bank_mask:0xf
    v_add_f32 v5, v5, v6
    v_max_f32 v10, v10, v5
    ds_write_b32 v72, v5 offset:0
    v_mfma_f32_16x16x32_bf16 v[16:19], v[100:103], v[44:47], v[16:19]
    s_waitcnt vmcnt(19)
    buffer_load_dwordx4 v[100:103], v1, s[8:11], s16 offen offset:0 nt
    s_xor_b32 s16, s16, s70
    v_mfma_f32_16x16x32_bf16 v[20:23], v[104:107], v[32:35], 0
    s_waitcnt vmcnt(19)
    buffer_load_dwordx4 v[104:107], v1, s[8:11], s16 offen offset:0 nt
    s_xor_b32 s16, s16, s68
    v_mfma_f32_16x16x32_bf16 v[20:23], v[108:111], v[36:39], v[20:23]
    s_waitcnt vmcnt(19)
    buffer_load_dwordx4 v[108:111], v1, s[8:11], s16 offen offset:0 nt
    s_xor_b32 s16, s16, s69
    s_cmp_eq_u32 s21, s3
    s_cbranch_scc1 L_pub_k0_0
L_pubx_k0_0:
    global_load_dword v54, v73, s[64:65] sc1
    v_mov_b32_dpp v5, v16 quad_perm:[0,0,0,0] row_mask:0xf bank_mask:0xf
    v_mov_b32_dpp v6, v18 quad_perm:[2,2,2,2] row_mask:0xf bank_mask:0xf
    v_mfma_f32_16x16x32_bf16 v[20:23], v[112:115], v[40:43], v[20:23]
    s_waitcnt vmcnt(20)
    buffer_load_dwordx4 v[112:115], v1, s[8:11], s16 offen offset:0 nt
    s_xor_b32 s16, s16, s68
    v_add_f32_dpp v5, v17, v5 quad_perm:[1,1,1,1] row_mask:0xf bank_mask:0xf
    v_add_f32_dpp v6, v19, v6 quad_perm:[3,3,3,3] row_mask:0xf bank_mask:0xf
    v_add_f32 v5, v5, v6
    v_max_f32 v10, v10, v5
    ds_write_b32 v72, v5 offset:64
    v_mfma_f32_16x16x32_bf16 v[20:23], v[116:119], v[44:47], v[20:23]
    s_waitcnt vmcnt(20)
    buffer_load_dwordx4 v[116:119], v1, s[8:11], s16 offen offset:0 nt
    s_xor_b32 s16, s16, s71
    v_mfma_f32_16x16x32_bf16 v[16:19], v[120:123], v[32:35], 0
    s_waitcnt vmcnt(20)
    buffer_load_dwordx4 v[120:123], v1, s[8:11], s16 offen offset:0 nt
    s_xor_b32 s16, s16, s68
    s_add_u32 s17, s17, 1
    s_bfe_u32 s12, s17, 0x10000
    s_lshl_b32 s12, s12, 17
    s_xor_b32 s13, s14, s12
    v_mfma_f32_16x16x32_bf16 v[16:19], v[124:127], v[36:39], v[16:19]
    s_waitcnt vmcnt(20)
    buffer_load_dwordx4 v[124:127], v1, s[8:11], s16 offen offset:0 nt
    s_xor_b32 s16, s16, s69
    s_bfe_u32 s12, s17, 0x10001
    s_lshl_b32 s12, s12, 9
    s_xor_b32 s13, s13, s12
    v_mov_b32_dpp v5, v20 quad_perm:[0,0,0,0] row_mask:0xf bank_mask:0xf
    v_mov_b32_dpp v6, v22 quad_perm:[2,2,2,2] row_mask:0xf bank_mask:0xf
    v_mfma_f32_16x16x32_bf16 v[16:19], v[128:131], v[40:43], v[16:19]
    s_waitcnt vmcnt(20)
    buffer_load_dwordx4 v[128:131], v1, s[8:11], s16 offen offset:0 nt
    s_xor_b32 s16, s16, s68
    s_bfe_u32 s12, s17, 0x30002
    s_lshl_b32 s12, s12, 18
    s_xor_b32 s13, s13, s12
    v_add_f32_dpp v5, v21, v5 quad_perm:[1,1,1,1] row_mask:0xf bank_mask:0xf
    v_add_f32_dpp v6, v23, v6 quad_perm:[3,3,3,3] row_mask:0xf bank_mask:0xf
    v_add_f32 v5, v5, v6
    v_max_f32 v10, v10, v5
    ds_write_b32 v72, v5 offset:128
    v_mfma_f32_16x16x32_bf16 v[16:19], v[132:135], v[44:47], v[16:19]
    s_waitcnt vmcnt(20)
    buffer_load_dwordx4 v[132:135], v1, s[8:11], s16 offen offset:0 nt
    s_xor_b32 s16, s16, s70
    v_mfma_f32_16x16x32_bf16 v[20:23], v[136:139], v[32:35], 0
    s_waitcnt vmcnt(20)
    buffer_load_dwordx4 v[136:139], v1, s[8:11], s16 offen offset:0 nt
    s_xor_b32 s16, s16, s68
    v_mfma_f32_16x16x32_bf16 v[20:23], v[140:143], v[36:39], v[20:23]
    s_waitcnt vmcnt(20)
    buffer_load_dwordx4 v[140:143], v1, s[8:11], s16 offen offset:0 nt
    s_xor_b32 s16, s16, s69
    v_mov_b32_dpp v5, v16 quad_perm:[0,0,0,0] row_mask:0xf bank_mask:0xf
    v_mov_b32_dpp v6, v18 quad_perm:[2,2,2,2] row_mask:0xf bank_mask:0xf
    v_mfma_f32_16x16x32_bf16 v[20:23], v[144:147], v[40:43], v[20:23]
    s_waitcnt vmcnt(20)
    buffer_load_dwordx4 v[144:147], v1, s[8:11], s16 offen offset:0 nt
    s_xor_b32 s16, s16, s68
    v_add_f32_dpp v5, v17, v5 quad_perm:[1,1,1,1] row_mask:0xf bank_mask:0xf
    v_add_f32_dpp v6, v19, v6 quad_perm:[3,3,3,3] row_mask:0xf bank_mask:0xf
    v_add_f32 v5, v5, v6
    v_max_f32 v10, v10, v5
    ds_write_b32 v72, v5 offset:192
    v_mfma_f32_16x16x32_bf16 v[20:23], v[148:151], v[44:47], v[20:23]
    s_waitcnt vmcnt(20)
    buffer_load_dwordx4 v[148:151], v1, s[8:11], s16 offen offset:0 nt
    s_xor_b32 s16, s16, s71
    v_mfma_f32_16x16x32_bf16 v[16:19], v[152:155], v[32:35], 0
    s_waitcnt vmcnt(20)
    buffer_load_dwordx4 v[152:155], v1, s[8:11], s16 offen offset:1024 nt
    s_xor_b32 s16, s16, s68
    v_mfma_f32_16x16x32_bf16 v[16:19], v[156:159], v[36:39], v[16:19]
    s_waitcnt vmcnt(20)
    buffer_load_dwordx4 v[156:159], v1, s[8:11], s16 offen offset:1024 nt
    s_xor_b32 s16, s16, s69
    v_mov_b32_dpp v5, v20 quad_perm:[0,0,0,0] row_mask:0xf bank_mask:0xf
    v_mov_b32_dpp v6, v22 quad_perm:[2,2,2,2] row_mask:0xf bank_mask:0xf
    v_mfma_f32_16x16x32_bf16 v[16:19], v[160:163], v[40:43], v[16:19]
    s_waitcnt vmcnt(20)
    buffer_load_dwordx4 v[160:163], v1, s[8:11], s16 offen offset:1024 nt
    s_xor_b32 s16, s16, s68
    v_add_f32_dpp v5, v21, v5 quad_perm:[1,1,1,1] row_mask:0xf bank_mask:0xf
    v_add_f32_dpp v6, v23, v6 quad_perm:[3,3,3,3] row_mask:0xf bank_mask:0xf
    v_add_f32 v5, v5, v6
    v_max_f32 v10, v10, v5
    ds_write_b32 v72, v5 offset:256
    v_mfma_f32_16x16x32_bf16 v[16:19], v[164:167], v[44:47], v[16:19]
    s_waitcnt vmcnt(20)
    buffer_load_dwordx4 v[164:167], v1, s[8:11], s16 offen offset:1024 nt
    s_xor_b32 s16, s16, s70
    v_mfma_f32_16x16x32_bf16 v[20:23], v[168:171], v[32:35], 0
    s_waitcnt vmcnt(20)
    buffer_load_dwordx4 v[168:171], v1, s[8:11], s16 offen offset:1024 nt
    s_xor_b32 s16, s16, s68
    v_mfma_f32_16x16x32_bf16 v[20:23], v[172:175], v[36:39], v[20:23]
    s_waitcnt vmcnt(20)
    buffer_load_dwordx4 v[172:175], v1, s[8:11], s16 offen offset:1024 nt
    s_xor_b32 s16, s16, s69
    v_mov_b32_dpp v5, v16 quad_perm:[0,0,0,0] row_mask:0xf bank_mask:0xf
    v_mov_b32_dpp v6, v18 quad_perm:[2,2,2,2] row_mask:0xf bank_mask:0xf
    v_mfma_f32_16x16x32_bf16 v[20:23], v[176:179], v[40:43], v[20:23]
    s_waitcnt vmcnt(20)
    buffer_load_dwordx4 v[176:179], v1, s[8:11], s16 offen offset:1024 nt
    s_xor_b32 s16, s16, s68
    v_add_f32_dpp v5, v17, v5 quad_perm:[1,1,1,1] row_mask:0xf bank_mask:0xf
    v_add_f32_dpp v6, v19, v6 quad_perm:[3,3,3,3] row_mask:0xf bank_mask:0xf
    v_add_f32 v5, v5, v6
    v_max_f32 v10, v10, v5
    ds_write_b32 v72, v5 offset:320
    v_mfma_f32_16x16x32_bf16 v[20:23], v[180:183], v[44:47], v[20:23]
    s_waitcnt vmcnt(20)
    buffer_load_dwordx4 v[180:183], v1, s[8:11], s16 offen offset:1024 nt
    s_xor_b32 s16, s16, s71
    v_mfma_f32_16x16x32_bf16 v[16:19], v[184:187], v[32:35], 0
    s_waitcnt vmcnt(20)
    buffer_load_dwordx4 v[184:187], v1, s[8:11], s16 offen offset:1024 nt
    s_xor_b32 s16, s16, s68
    v_mfma_f32_16x16x32_bf16 v[16:19], v[188:191], v[36:39], v[16:19]
    s_waitcnt vmcnt(19)
    buffer_load_dwordx4 v[188:191], v1, s[8:11], s16 offen offset:1024 nt
    s_xor_b32 s16, s16, s69
    s_cmp_eq_u32 s21, s6
    s_cbranch_scc1 L_pub_k0_1
L_pubx_k0_1:
    v_mov_b32_dpp v5, v20 quad_perm:[0,0,0,0] row_mask:0xf bank_mask:0xf
    v_mov_b32_dpp v6, v22 quad_perm:[2,2,2,2] row_mask:0xf bank_mask:0xf
    v_mfma_f32_16x16x32_bf16 v[16:19], v[192:195], v[40:43], v[16:19]
    s_waitcnt vmcnt(19)
    buffer_load_dwordx4 v[192:195], v1, s[8:11], s16 offen offset:1024 nt
    s_xor_b32 s16, s16, s68
    v_add_f32_dpp v5, v21, v5 quad_perm:[1,1,1,1] row_mask:0xf bank_mask:0xf
    v_add_f32_dpp v6, v23, v6 quad_perm:[3,3,3,3] row_mask:0xf bank_mask:0xf
    v_add_f32 v5, v5, v6
    v_max_f32 v10, v10, v5
    ds_write_b32 v72, v5 offset:384
    v_mfma_f32_16x16x32_bf16 v[16:19], v[196:199], v[44:47], v[16:19]
    s_waitcnt vmcnt(19)
    buffer_load_dwordx4 v[196:199], v1, s[8:11], s16 offen offset:1024 nt
    s_xor_b32 s16, s16, s70
    v_readlane_b32 s42, v74, s21
    s_add_u32 s49, s49, s50
    s_lshr_b32 s22, s49, 4
    s_and_b32 s49, s49, 15
    v_mfma_f32_16x16x32_bf16 v[20:23], v[200:203], v[32:35], 0
    s_waitcnt vmcnt(19)
    buffer_load_dwordx4 v[200:203], v1, s[8:11], s16 offen offset:1024 nt
    s_xor_b32 s16, s16, s68
    v_mfma_f32_16x16x32_bf16 v[20:23], v[204:207], v[36:39], v[20:23]
    s_waitcnt vmcnt(19)
    buffer_load_dwordx4 v[204:207], v1, s[8:11], s16 offen offset:1024 nt
    s_xor_b32 s16, s16, s69
    v_readlane_b32 s23, v54, s21
    v_mov_b32_dpp v5, v16 quad_perm:[0,0,0,0] row_mask:0xf bank_mask:0xf
    v_mov_b32_dpp v6, v18 quad_perm:[2,2,2,2] row_mask:0xf bank_mask:0xf
    v_mfma_f32_16x16x32_bf16 v[20:23], v[208:211], v[40:43], v[20:23]
    s_waitcnt vmcnt(19)
    buffer_load_dwordx4 v[208:211], v1, s[8:11], s16 offen offset:1024 nt
    s_xor_b32 s16, s16, s68
    s_xor_b32 s42, s42, s23
    s_bcnt1_i32_b32 s42, s42
    s_lshr_b32 s42, 0x90100, s42
    s_and_b32 s42, s42, 15
    s_add_u32 s22, s22, s42
    v_add_f32_dpp v5, v17, v5 quad_perm:[1,1,1,1] row_mask:0xf bank_mask:0xf
    v_add_f32_dpp v6, v19, v6 quad_perm:[3,3,3,3] row_mask:0xf bank_mask:0xf
    v_add_f32 v5, v5, v6
    v_max_f32 v10, v10, v5
    ds_write_b32 v72, v5 offset:448
    v_mfma_f32_16x16x32_bf16 v[20:23], v[212:215], v[44:47], v[20:23]
    s_waitcnt vmcnt(19)
    buffer_load_dwordx4 v[212:215], v1, s[8:11], s16 offen offset:1024 nt
    s_mov_b32 s16, s13
    v_add_u32 v72, 512, v72
    s_add_u32 s21, s21, 1
    s_cmp_eq_u32 s21, s66
    s_cbranch_scc1 L_kev
    s_cmp_eq_u32 s22, 1
    s_cbranch_scc1 L_k1
    s_cmp_eq_u32 s22, 2
    s_cbranch_scc1 L_k2
    s_cmp_eq_u32 s22, 0
    s_cbranch_scc1 L_k0
    s_branch L_k3
L_pub_k0_0:
    s_mov_b64 exec, s[4:5]
    global_store_byte v73, v75, s[64:65]
    s_mov_b64 exec, -1
    s_add_u32 s3, s3, 32
    s_branch L_pubx_k0_0
L_pub_k0_1:
    s_mov_b64 exec, s[4:5]
    global_store_short v73, v75, s[64:65]
    s_mov_b64 exec, -1
    s_add_u32 s6, s6, 32
    s_lshl_b64 s[4:5], s[4:5], 32
    s_branch L_pubx_k0_1
L_k2:
    v_mfma_f32_16x16x32_bf16 v[16:19], v[88:91], v[32:35], 0
    s_waitcnt vmcnt(21)
    buffer_load_dwordx4 v[88:91], v1, s[8:11], s16 offen offset:0 nt
    s_xor_b32 s16, s16, s68
    v_mfma_f32_16x16x32_bf16 v[16:19], v[92:95], v[36:39], v[16:19]
    s_waitcnt vmcnt(21)
    buffer_load_dwordx4 v[92:95], v1, s[8:11], s16 offen offset:0 nt
    s_xor_b32 s16, s16, s69
    v_mov_b32_dpp v5, v20 quad_perm:[0,0,0,0] row_mask:0xf bank_mask:0xf
    v_mov_b32_dpp v6, v22 quad_perm:[2,2,2,2] row_mask:0xf bank_mask:0xf
    v_mfma_f32_16x16x32_bf16 v[16:19], v[96:99], v[40:43], v[16:19]
    s_waitcnt vmcnt(21)
    buffer_load_dwordx4 v[96:99], v1, s[8:11], s16 offen offset:0 nt
    s_xor_b32 s16, s16, s68
    v_add_f32_dpp v5, v21, v5 quad_perm:[1,1,1,1] row_mask:0xf bank_mask:0xf
    v_add_f32_dpp v6, v23, v6 quad_perm:[3,3,3,3] row_mask:0xf bank_mask:0xf
    v_add_f32 v5, v5, v6
    v_max_f32 v10, v10, v5
    ds_write_b32 v72, v5 offset:0
    v_mfma_f32_16x16x32_bf16 v[16:19], v[100:103], v[44:47], v[16:19]
    s_waitcnt vmcnt(21)
    buffer_load_dwordx4 v[100:103], v1, s[8:11], s16 offen offset:0 nt
    s_xor_b32 s16, s16, s70
    v_mfma_f32_16x16x32_bf16 v[20:23], v[104:107], v[32:35], 0
    s_waitcnt vmcnt(21)
    buffer_load_dwordx4 v[104:107], v1, s[8:11], s16 offen offset:0 nt
    s_xor_b32 s16, s16, s68
    v_mfma_f32_16x16x32_bf16 v[20:23], v[108:111], v[36:39], v[20:23]
    s_waitcnt vmcnt(21)
    buffer_load_dwordx4 v[108:111], v1, s[8:11], s16 offen offset:0 nt
    s_xor_b32 s16, s16, s69
    s_cmp_eq_u32 s21, s3
    s_cbranch_scc1 L_pub_k2_0
L_pubx_k2_0:
    global_load_dword v54, v73, s[64:65] sc1
    v_mov_b32_dpp v5, v16 quad_perm:[0,0,0,0] row_mask:0xf bank_mask:0xf
    v_mov_b32_dpp v6, v18 quad_perm:[2,2,2,2] row_mask:0xf bank_mask:0xf
    v_mfma_f32_16x16x32_bf16 v[20:23], v[112:115], v[40:43], v[20:23]
    s_waitcnt vmcnt(22)
    buffer_load_dwordx4 v[112:115], v1, s[8:11], s16 offen offset:0 nt
    s_xor_b32 s16, s16, s68
    v_add_f32_dpp v5, v17, v5 quad_perm:[1,1,1,1] row_mask:0xf bank_mask:0xf
    v_add_f32_dpp v6, v19, v6 quad_perm:[3,3,3,3] row_mask:0xf bank_mask:0xf
    v_add_f32 v5, v5, v6
    v_max_f32 v10, v10, v5
    ds_write_b32 v72, v5 offset:64
    v_mfma_f32_16x16x32_bf16 v[20:23], v[116:119], v[44:47], v[20:23]
    s_waitcnt vmcnt(22)
    buffer_load_dwordx4 v[116:119], v1, s[8:11], s16 offen offset:0 nt
    s_xor_b32 s16, s16, s71
    v_mfma_f32_16x16x32_bf16 v[16:19], v[120:123], v[32:35], 0
    s_waitcnt vmcnt(22)
    buffer_load_dwordx4 v[120:123], v1, s[8:11], s16 offen offset:0 nt
    s_xor_b32 s16, s16, s68
    s_add_u32 s17, s17, 1
    s_bfe_u32 s12, s17, 0x10000
    s_lshl_b32 s12, s12, 17
    s_xor_b32 s13, s14, s12
    v_mfma_f32_16x16x32_bf16 v[16:19], v[124:127], v[36:39], v[16:19]
    s_waitcnt vmcnt(22)
    buffer_load_dwordx4 v[124:127], v1, s[8:11], s16 offen offset:0 nt
    s_xor_b32 s16, s16, s69
    s_bfe_u32 s12, s17, 0x10001
    s_lshl_b32 s12, s12, 9
    s_xor_b32 s13, s13, s12
    v_mov_b32_dpp v5, v20 quad_perm:[0,0,0,0] row_mask:0xf bank_mask:0xf
    v_mov_b32_dpp v6, v22 quad_perm:[2,2,2,2] row_mask:0xf bank_mask:0xf
    v_mfma_f32_16x16x32_bf16 v[16:19], v[128:131], v[40:43], v[16:19]
    s_waitcnt vmcnt(22)
    buffer_load_dwordx4 v[128:131], v1, s[8:11], s16 offen offset:0 nt
    s_xor_b32 s16, s16, s68
    s_bfe_u32 s12, s17, 0x30002
    s_lshl_b32 s12, s12, 18
    s_xor_b32 s13, s13, s12
    v_add_f32_dpp v5, v21, v5 quad_perm:[1,1,1,1] row_mask:0xf bank_mask:0xf
    v_add_f32_dpp v6, v23, v6 quad_perm:[3,3,3,3] row_mask:0xf bank_mask:0xf
    v_add_f32 v5, v5, v6
    v_max_f32 v10, v10, v5
    ds_write_b32 v72, v5 offset:128
    v_mfma_f32_16x16x32_bf16 v[16:19], v[132:135], v[44:47], v[16:19]
    s_waitcnt vmcnt(22)
    buffer_load_dwordx4 v[132:135], v1, s[8:11], s16 offen offset:0 nt
    s_xor_b32 s16, s16, s70
    v_mfma_f32_16x16x32_bf16 v[20:23], v[136:139], v[32:35], 0
    s_waitcnt vmcnt(22)
    buffer_load_dwordx4 v[136:139], v1, s[8:11], s16 offen offset:0 nt
    s_xor_b32 s16, s16, s68
    v_mfma_f32_16x16x32_bf16 v[20:23], v[140:143], v[36:39], v[20:23]
    s_waitcnt vmcnt(22)
    buffer_load_dwordx4 v[140:143], v1, s[8:11], s16 offen offset:0 nt
    s_xor_b32 s16, s16, s69
    v_mov_b32_dpp v5, v16 quad_perm:[0,0,0,0] row_mask:0xf bank_mask:0xf
    v_mov_b32_dpp v6, v18 quad_perm:[2,2,2,2] row_mask:0xf bank_mask:0xf
    v_mfma_f32_16x16x32_bf16 v[20:23], v[144:147], v[40:43], v[20:23]
    s_waitcnt vmcnt(22)
    buffer_load_dwordx4 v[144:147], v1, s[8:11], s16 offen offset:0 nt
    s_xor_b32 s16, s16, s68
    v_add_f32_dpp v5, v17, v5 quad_perm:[1,1,1,1] row_mask:0xf bank_mask:0xf
    v_add_f32_dpp v6, v19, v6 quad_perm:[3,3,3,3] row_mask:0xf bank_mask:0xf
    v_add_f32 v5, v5, v6
    v_max_f32 v10, v10, v5
    ds_write_b32 v72, v5 offset:192
    v_mfma_f32_16x16x32_bf16 v[20:23], v[148:151], v[44:47], v[20:23]
    s_waitcnt vmcnt(22)
    buffer_load_dwordx4 v[148:151], v1, s[8:11], s16 offen offset:0 nt
    s_xor_b32 s16, s16, s71
    v_mfma_f32_16x16x32_bf16 v[16:19], v[152:155], v[32:35], 0
    s_waitcnt vmcnt(22)
    buffer_load_dwordx4 v[152:155], v1, s[8:11], s16 offen offset:1024 nt
    s_xor_b32 s16, s16, s68
    v_mfma_f32_16x16x32_bf16 v[16:19], v[156:159], v[36:39], v[16:19]
    s_waitcnt vmcnt(22)
    buffer_load_dwordx4 v[156:159], v1, s[8:11], s16 offen offset:1024 nt
    s_xor_b32 s16, s16, s69
    v_mov_b32_dpp v5, v20 quad_perm:[0,0,0,0] row_mask:0xf bank_mask:0xf
    v_mov_b32_dpp v6, v22 quad_perm:[2,2,2,2] row_mask:0xf bank_mask:0xf
    v_mfma_f32_16x16x32_bf16 v[16:19], v[160:163], v[40:43], v[16:19]
    s_waitcnt vmcnt(22)
    buffer_load_dwordx4 v[160:163], v1, s[8:11], s16 offen offset:1024 nt
    s_xor_b32 s16, s16, s68
    v_add_f32_dpp v5, v21, v5 quad_perm:[1,1,1,1] row_mask:0xf bank_mask:0xf
    v_add_f32_dpp v6, v23, v6 quad_perm:[3,3,3,3] row_mask:0xf bank_mask:0xf
    v_add_f32 v5, v5, v6
    v_max_f32 v10, v10, v5
    ds_write_b32 v72, v5 offset:256
    v_mfma_f32_16x16x32_bf16 v[16:19], v[164:167], v[44:47], v[16:19]
    s_waitcnt vmcnt(22)
    buffer_load_dwordx4 v[164:167], v1, s[8:11], s16 offen offset:1024 nt
    s_xor_b32 s16, s16, s70
    v_mfma_f32_16x16x32_bf16 v[20:23], v[168:171], v[32:35], 0
    s_waitcnt vmcnt(22)
    buffer_load_dwordx4 v[168:171], v1, s[8:11], s16 offen offset:1024 nt
    s_xor_b32 s16, s16, s68
    v_mfma_f32_16x16x32_bf16 v[20:23], v[172:175], v[36:39], v[20:23]
    s_waitcnt vmcnt(22)
    buffer_load_dwordx4 v[172:175], v1, s[8:11], s16 offen offset:1024 nt
    s_xor_b32 s16, s16, s69
    v_mov_b32_dpp v5, v16 quad_perm:[0,0,0,0] row_mask:0xf bank_mask:0xf
    v_mov_b32_dpp v6, v18 quad_perm:[2,2,2,2] row_mask:0xf bank_mask:0xf
    v_mfma_f32_16x16x32_bf16 v[20:23], v[176:179], v[40:43], v[20:23]
    s_waitcnt vmcnt(22)
    buffer_load_dwordx4 v[176:179], v1, s[8:11], s16 offen offset:1024 nt
    s_xor_b32 s16, s16, s68
    v_add_f32_dpp v5, v17, v5 quad_perm:[1,1,1,1] row_mask:0xf bank_mask:0xf
    v_add_f32_dpp v6, v19, v6 quad_perm:[3,3,3,3] row_mask:0xf bank_mask:0xf
    v_add_f32 v5, v5, v6
    v_max_f32 v10, v10, v5
    ds_write_b32 v72, v5 offset:320
    v_mfma_f32_16x16x32_bf16 v[20:23], v[180:183], v[44:47], v[20:23]
    s_waitcnt vmcnt(22)
    buffer_load_dwordx4 v[180:183], v1, s[8:11], s16 offen offset:1024 nt
    s_xor_b32 s16, s16, s71
    v_mfma_f32_16x16x32_bf16 v[16:19], v[184:187], v[32:35], 0
    s_waitcnt vmcnt(22)
    buffer_load_dwordx4 v[184:187], v1, s[8:11], s16 offen offset:1024 nt
    s_xor_b32 s16, s16, s68
    v_mfma_f32_16x16x32_bf16 v[16:19], v[188:191], v[36:39], v[16:19]
    s_waitcnt vmcnt(22)
    buffer_load_dwordx4 v[188:191], v1, s[8:11], s16 offen offset:1024 nt
    s_xor_b32 s16, s16, s69
    s_cmp_eq_u32 s21, s6
    s_cbranch_scc1 L_pub_k2_1
L_pubx_k2_1:
    v_mov_b32_dpp v5, v20 quad_perm:[0,0,0,0] row_mask:0xf bank_mask:0xf
    v_mov_b32_dpp v6, v22 quad_perm:[2,2,2,2] row_mask:0xf bank_mask:0xf
    v_mfma_f32_16x16x32_bf16 v[16:19], v[192:195], v[40:43], v[16:19]
    s_waitcnt vmcnt(22)
    buffer_load_dwordx4 v[192:195], v1, s[8:11], s16 offen offset:1024 nt
    s_xor_b32 s16, s16, s68
    v_add_f32_dpp v5, v21, v5 quad_perm:[1,1,1,1] row_mask:0xf bank_mask:0xf
    v_add_f32_dpp v6, v23, v6 quad_perm:[3,3,3,3] row_mask:0xf bank_mask:0xf
    v_add_f32 v5, v5, v6
    v_max_f32 v10, v10, v5
    ds_write_b32 v72, v5 offset:384
    v_mfma_f32_16x16x32_bf16 v[16:19], v[196:199], v[44:47], v[16:19]
    s_waitcnt vmcnt(21)
    buffer_load_dwordx4 v[196:199], v1, s[8:11], s16 offen offset:1024 nt
    s_xor_b32 s16, s16, s70
    v_readlane_b32 s42, v74, s21
    s_add_u32 s49, s49, s50
    s_lshr_b32 s22, s49, 4
    s_and_b32 s49, s49, 15
    v_mfma_f32_16x16x32_bf16 v[20:23], v[200:203], v[32:35], 0
    s_waitcnt vmcnt(21)
    buffer_load_dwordx4 v[200:203], v1, s[8:11], s16 offen offset:1024 nt
    s_xor_b32 s16, s16, s68
    v_mfma_f32_16x16x32_bf16 v[20:23], v[204:207], v[36:39], v[20:23]
    s_waitcnt vmcnt(21)
    buffer_load_dwordx4 v[204:207], v1, s[8:11], s16 offen offset:1024 nt
    s_xor_b32 s16, s16, s69
    v_readlane_b32 s23, v54, s21
    v_mov_b32_dpp v5, v16 quad_perm:[0,0,0,0] row_mask:0xf bank_mask:0xf
    v_mov_b32_dpp v6, v18 quad_perm:[2,2,2,2] row_mask:0xf bank_mask:0xf
    v_mfma_f32_16x16x32_bf16 v[20:23], v[208:211], v[40:43], v[20:23]
    s_waitcnt vmcnt(21)
    buffer_load_dwordx4 v[208:211], v1, s[8:11], s16 offen offset:1024 nt
    s_xor_b32 s16, s16, s68
    s_xor_b32 s42, s42, s23
    s_bcnt1_i32_b32 s42, s42
    s_lshr_b32 s42, 0x90100, s42
    s_and_b32 s42, s42, 15
    s_add_u32 s22, s22, s42
    v_add_f32_dpp v5, v17, v5 quad_perm:[1,1,1,1] row_mask:0xf bank_mask:0xf
    v_add_f32_dpp v6, v19, v6 quad_perm:[3,3,3,3] row_mask:0xf bank_mask:0xf
    v_add_f32 v5, v5, v6
    v_max_f32 v10, v10, v5
    ds_write_b32 v72, v5 offset:448
    v_mfma_f32_16x16x32_bf16 v[20:23], v[212:215], v[44:47], v[20:23]
    s_waitcnt vmcnt(21)
    buffer_load_dwordx4 v[212:215], v1, s[8:11], s16 offen offset:1024 nt
    s_mov_b32 s16, s13
    v_add_u32 v72, 512, v72
    s_add_u32 s21, s21, 1
    s_cmp_eq_u32 s21, s66
    s_cbranch_scc1 L_kev
    s_cmp_eq_u32 s22, 1
    s_cbranch_scc1 L_k1
    s_cmp_eq_u32 s22, 2
    s_cbranch_scc1 L_k2
    s_cmp_eq_u32 s22, 0
    s_cbranch_scc1 L_k0
    s_branch L_k3
L_pub_k2_0:
    s_mov_b64 exec, s[4:5]
    global_store_byte v73, v75, s[64:65]
    s_mov_b64 exec, -1
    s_add_u32 s3, s3, 32
    s_branch L_pubx_k2_0
L_pub_k2_1:
    s_mov_b64 exec, s[4:5]
    global_store_short v73, v75, s[64:65]
    s_mov_b64 exec, -1
    s_add_u32 s6, s6, 32
    s_lshl_b64 s[4:5], s[4:5], 32
    s_branch L_pubx_k2_1
L_k3:
    v_mfma_f32_16x16x32_bf16 v[16:19], v[88:91], v[32:35], 0
    s_waitcnt vmcnt(23)
    buffer_load_dwordx4 v[88:91], v1, s[8:11], s16 offen offset:0 nt
    s_xor_b32 s16, s16, s68
    v_mfma_f32_16x16x32_bf16 v[16:19], v[92:95], v[36:39], v[16:19]
    s_waitcnt vmcnt(23)
    buffer_load_dwordx4 v[92:95], v1, s[8:11], s16 offen offset:0 nt
    s_xor_b32 s16, s16, s69
    v_mov_b32_dpp v5, v20 quad_perm:[0,0,0,0] row_mask:0xf bank_mask:0xf
    v_mov_b32_dpp v6, v22 quad_perm:[2,2,2,2] row_mask:0xf bank_mask:0xf
    v_mfma_f32_16x16x32_bf16 v[16:19], v[96:99], v[40:43], v[16:19]
    s_waitcnt vmcnt(23)
    buffer_load_dwordx4 v[96:99], v1, s[8:11], s16 offen offset:0 nt
    s_xor_b32 s16, s16, s68
    v_add_f32_dpp v5, v21, v5 quad_perm:[1,1,1,1] row_mask:0xf bank_mask:0xf
    v_add_f32_dpp v6, v23, v6 quad_perm:[3,3,3,3] row_mask:0xf bank_mask:0xf
    v_add_f32 v5, v5, v6
    v_max_f32 v10, v10, v5
    ds_write_b32 v72, v5 offset:0
    v_mfma_f32_16x16x32_bf16 v[16:19], v[100:103], v[44:47], v[16:19]
    s_waitcnt vmcnt(23)
    buffer_load_dwordx4 v[100:103], v1, s[8:11], s16 offen offset:0 nt
    s_xor_b32 s16, s16, s70
    v_mfma_f32_16x16x32_bf16 v[20:23], v[104:107], v[32:35], 0
    s_waitcnt vmcnt(23)
    buffer_load_dwordx4 v[104:107], v1, s[8:11], s16 offen offset:0 nt
    s_xor_b32 s16, s16, s68
    v_mfma_f32_16x16x32_bf16 v[20:23], v[108:111], v[36:39], v[20:23]
    s_waitcnt vmcnt(23)
    buffer_load_dwordx4 v[108:111], v1, s[8:11], s16 offen offset:0 nt
    s_xor_b32 s16, s16, s69
    s_cmp_eq_u32 s21, s3
    s_cbranch_scc1 L_pub_k3_0
L_pubx_k3_0:
    global_load_dword v54, v73, s[64:65] sc1
    v_mov_b32_dpp v5, v16 quad_perm:[0,0,0,0] row_mask:0xf bank_mask:0xf
    v_mov_b32_dpp v6, v18 quad_perm:[2,2,2,2] row_mask:0xf bank_mask:0xf
    v_mfma_f32_16x16x32_bf16 v[20:23], v[112:115], v[40:43], v[20:23]
    s_waitcnt vmcnt(24)
    buffer_load_dwordx4 v[112:115], v1, s[8:11], s16 offen offset:0 nt
    s_xor_b32 s16, s16, s68
    v_add_f32_dpp v5, v17, v5 quad_perm:[1,1,1,1] row_mask:0xf bank_mask:0xf
    v_add_f32_dpp v6, v19, v6 quad_perm:[3,3,3,3] row_mask:0xf bank_mask:0xf
    v_add_f32 v5, v5, v6
    v_max_f32 v10, v10, v5
    ds_write_b32 v72, v5 offset:64
    v_mfma_f32_16x16x32_bf16 v[20:23], v[116:119], v[44:47], v[20:23]
    s_waitcnt vmcnt(24)
    buffer_load_dwordx4 v[116:119], v1, s[8:11], s16 offen offset:0 nt
    s_xor_b32 s16, s16, s71
    v_mfma_f32_16x16x32_bf16 v[16:19], v[120:123], v[32:35], 0
    s_waitcnt vmcnt(24)
    buffer_load_dwordx4 v[120:123], v1, s[8:11], s16 offen offset:0 nt
    s_xor_b32 s16, s16, s68
    s_add_u32 s17, s17, 1
    s_bfe_u32 s12, s17, 0x10000
    s_lshl_b32 s12, s12, 17
    s_xor_b32 s13, s14, s12
    v_mfma_f32_16x16x32_bf16 v[16:19], v[124:127], v[36:39], v[16:19]
    s_waitcnt vmcnt(24)
    buffer_load_dwordx4 v[124:127], v1, s[8:11], s16 offen offset:0 nt
    s_xor_b32 s16, s16, s69
    s_bfe_u32 s12, s17, 0x10001
    s_lshl_b32 s12, s12, 9
    s_xor_b32 s13, s13, s12
    v_mov_b32_dpp v5, v20 quad_perm:[0,0,0,0] row_mask:0xf bank_mask:0xf
    v_mov_b32_dpp v6, v22 quad_perm:[2,2,2,2] row_mask:0xf bank_mask:0xf
    v_mfma_f32_16x16x32_bf16 v[16:19], v[128:131], v[40:43], v[16:19]
    s_waitcnt vmcnt(24)
    buffer_load_dwordx4 v[128:131], v1, s[8:11], s16 offen offset:0 nt
    s_xor_b32 s16, s16, s68
    s_bfe_u32 s12, s17, 0x30002
    s_lshl_b32 s12, s12, 18
    s_xor_b32 s13, s13, s12
    v_add_f32_dpp v5, v21, v5 quad_perm:[1,1,1,1] row_mask:0xf bank_mask:0xf
    v_add_f32_dpp v6, v23, v6 quad_perm:[3,3,3,3] row_mask:0xf bank_mask:0xf
    v_add_f32 v5, v5, v6
    v_max_f32 v10, v10, v5
    ds_write_b32 v72, v5 offset:128
    v_mfma_f32_16x16x32_bf16 v[16:19], v[132:135], v[44:47], v[16:19]
    s_waitcnt vmcnt(24)
    buffer_load_dwordx4 v[132:135], v1, s[8:11], s16 offen offset:0 nt
    s_xor_b32 s16, s16, s70
    v_mfma_f32_16x16x32_bf16 v[20:23], v[136:139], v[32:35], 0
    s_waitcnt vmcnt(24)
    buffer_load_dwordx4 v[136:139], v1, s[8:11], s16 offen offset:0 nt
    s_xor_b32 s16, s16, s68
    v_mfma_f32_16x16x32_bf16 v[20:23], v[140:143], v[36:39], v[20:23]
    s_waitcnt vmcnt(24)
    buffer_load_dwordx4 v[140:143], v1, s[8:11], s16 offen offset:0 nt
    s_xor_b32 s16, s16, s69
    v_mov_b32_dpp v5, v16 quad_perm:[0,0,0,0] row_mask:0xf bank_mask:0xf
    v_mov_b32_dpp v6, v18 quad_perm:[2,2,2,2] row_mask:0xf bank_mask:0xf
    v_mfma_f32_16x16x32_bf16 v[20:23], v[144:147], v[40:43], v[20:23]
    s_waitcnt vmcnt(24)
    buffer_load_dwordx4 v[144:147], v1, s[8:11], s16 offen offset:0 nt
    s_xor_b32 s16, s16, s68
    v_add_f32_dpp v5, v17, v5 quad_perm:[1,1,1,1] row_mask:0xf bank_mask:0xf
    v_add_f32_dpp v6, v19, v6 quad_perm:[3,3,3,3] row_mask:0xf bank_mask:0xf
    v_add_f32 v5, v5, v6
    v_max_f32 v10, v10, v5
    ds_write_b32 v72, v5 offset:192
    v_mfma_f32_16x16x32_bf16 v[20:23], v[148:151], v[44:47], v[20:23]
    s_waitcnt vmcnt(24)
    buffer_load_dwordx4 v[148:151], v1, s[8:11], s16 offen offset:0 nt
    s_xor_b32 s16, s16, s71
    v_mfma_f32_16x16x32_bf16 v[16:19], v[152:155], v[32:35], 0
    s_waitcnt vmcnt(24)
    buffer_load_dwordx4 v[152:155], v1, s[8:11], s16 offen offset:1024 nt
    s_xor_b32 s16, s16, s68
    v_mfma_f32_16x16x32_bf16 v[16:19], v[156:159], v[36:39], v[16:19]
    s_waitcnt vmcnt(24)
    buffer_load_dwordx4 v[156:159], v1, s[8:11], s16 offen offset:1024 nt
    s_xor_b32 s16, s16, s69
    v_mov_b32_dpp v5, v20 quad_perm:[0,0,0,0] row_mask:0xf bank_mask:0xf
    v_mov_b32_dpp v6, v22 quad_perm:[2,2,2,2] row_mask:0xf bank_mask:0xf
    v_mfma_f32_16x16x32_bf16 v[16:19], v[160:163], v[40:43], v[16:19]
    s_waitcnt vmcnt(24)
    buffer_load_dwordx4 v[160:163], v1, s[8:11], s16 offen offset:1024 nt
    s_xor_b32 s16, s16, s68
    v_add_f32_dpp v5, v21, v5 quad_perm:[1,1,1,1] row_mask:0xf bank_mask:0xf
    v_add_f32_dpp v6, v23, v6 quad_perm:[3,3,3,3] row_mask:0xf bank_mask:0xf
    v_add_f32 v5, v5, v6
    v_max_f32 v10, v10, v5
    ds_write_b32 v72, v5 offset:256
    v_mfma_f32_16x16x32_bf16 v[16:19], v[164:167], v[44:47], v[16:19]
    s_waitcnt vmcnt(24)
    buffer_load_dwordx4 v[164:167], v1, s[8:11], s16 offen offset:1024 nt
    s_xor_b32 s16, s16, s70
    v_mfma_f32_16x16x32_bf16 v[20:23], v[168:171], v[32:35], 0
    s_waitcnt vmcnt(24)
    buffer_load_dwordx4 v[168:171], v1, s[8:11], s16 offen offset:1024 nt
    s_xor_b32 s16, s16, s68
    v_mfma_f32_16x16x32_bf16 v[20:23], v[172:175], v[36:39], v[20:23]
    s_waitcnt vmcnt(24)
    buffer_load_dwordx4 v[172:175], v1, s[8:11], s16 offen offset:1024 nt
    s_xor_b32 s16, s16, s69
    v_mov_b32_dpp v5, v16 quad_perm:[0,0,0,0] row_mask:0xf bank_mask:0xf
    v_mov_b32_dpp v6, v18 quad_perm:[2,2,2,2] row_mask:0xf bank_mask:0xf
    v_mfma_f32_16x16x32_bf16 v[20:23], v[176:179], v[40:43], v[20:23]
    s_waitcnt vmcnt(24)
    buffer_load_dwordx4 v[176:179], v1, s[8:11], s16 offen offset:1024 nt
    s_xor_b32 s16, s16, s68
    v_add_f32_dpp v5, v17, v5 quad_perm:[1,1,1,1] row_mask:0xf bank_mask:0xf
    v_add_f32_dpp v6, v19, v6 quad_perm:[3,3,3,3] row_mask:0xf bank_mask:0xf
    v_add_f32 v5, v5, v6
    v_max_f32 v10, v10, v5
    ds_write_b32 v72, v5 offset:320
    v_mfma_f32_16x16x32_bf16 v[20:23], v[180:183], v[44:47], v[20:23]
    s_waitcnt vmcnt(24)
    buffer_load_dwordx4 v[180:183], v1, s[8:11], s16 offen offset:1024 nt
    s_xor_b32 s16, s16, s71
    v_mfma_f32_16x16x32_bf16 v[16:19], v[184:187], v[32:35], 0
    s_waitcnt vmcnt(24)
    buffer_load_dwordx4 v[184:187], v1, s[8:11], s16 offen offset:1024 nt
    s_xor_b32 s16, s16, s68
    v_mfma_f32_16x16x32_bf16 v[16:19], v[188:191], v[36:39], v[16:19]
    s_waitcnt vmcnt(24)
    buffer_load_dwordx4 v[188:191], v1, s[8:11], s16 offen offset:1024 nt
    s_xor_b32 s16, s16, s69
    s_cmp_eq_u32 s21, s6
    s_cbranch_scc1 L_pub_k3_1
L_pubx_k3_1:
    v_mov_b32_dpp v5, v20 quad_perm:[0,0,0,0] row_mask:0xf bank_mask:0xf
    v_mov_b32_dpp v6, v22 quad_perm:[2,2,2,2] row_mask:0xf bank_mask:0xf
    v_mfma_f32_16x16x32_bf16 v[16:19], v[192:195], v[40:43], v[16:19]
    s_waitcnt vmcnt(24)
    buffer_load_dwordx4 v[192:195], v1, s[8:11], s16 offen offset:1024 nt
    s_xor_b32 s16, s16, s68
    v_add_f32_dpp v5, v21, v5 quad_perm:[1,1,1,1] row_mask:0xf bank_mask:0xf
    v_add_f32_dpp v6, v23, v6 quad_perm:[3,3,3,3] row_mask:0xf bank_mask:0xf
    v_add_f32 v5, v5, v6
    v_max_f32 v10, v10, v5
    ds_write_b32 v72, v5 offset:384
    v_mfma_f32_16x16x32_bf16 v[16:19], v[196:199], v[44:47], v[16:19]
    s_waitcnt vmcnt(24)
    buffer_load_dwordx4 v[196:199], v1, s[8:11], s16 offen offset:1024 nt
    s_xor_b32 s16, s16, s70
    v_readlane_b32 s42, v74, s21
    s_add_u32 s49, s49, s50
    s_lshr_b32 s22, s49, 4
    s_and_b32 s49, s49, 15
    v_mfma_f32_16x16x32_bf16 v[20:23], v[200:203], v[32:35], 0
    s_waitcnt vmcnt(24)
    buffer_load_dwordx4 v[200:203], v1, s[8:11], s16 offen offset:1024 nt
    s_xor_b32 s16, s16, s68
    v_mfma_f32_16x16x32_bf16 v[20:23], v[204:207], v[36:39], v[20:23]
    s_waitcnt vmcnt(23)
    buffer_load_dwordx4 v[204:207], v1, s[8:11], s16 offen offset:1024 nt
    s_xor_b32 s16, s16, s69
    v_readlane_b32 s23, v54, s21
    v_mov_b32_dpp v5, v16 quad_perm:[0,0,0,0] row_mask:0xf bank_mask:0xf
    v_mov_b32_dpp v6, v18 quad_perm:[2,2,2,2] row_mask:0xf bank_mask:0xf
    v_mfma_f32_16x16x32_bf16 v[20:23], v[208:211], v[40:43], v[20:23]
    s_waitcnt vmcnt(23)
    buffer_load_dwordx4 v[208:211], v1, s[8:11], s16 offen offset:1024 nt
    s_xor_b32 s16, s16, s68
    s_xor_b32 s42, s42, s23
    s_bcnt1_i32_b32 s42, s42
    s_lshr_b32 s42, 0x90100, s42
    s_and_b32 s42, s42, 15
    s_add_u32 s22, s22, s42
    v_add_f32_dpp v5, v17, v5 quad_perm:[1,1,1,1] row_mask:0xf bank_mask:0xf
    v_add_f32_dpp v6, v19, v6 quad_perm:[3,3,3,3] row_mask:0xf bank_mask:0xf
    v_add_f32 v5, v5, v6
    v_max_f32 v10, v10, v5
    ds_write_b32 v72, v5 offset:448
    v_mfma_f32_16x16x32_bf16 v[20:23], v[212:215], v[44:47], v[20:23]
    s_waitcnt vmcnt(23)
    buffer_load_dwordx4 v[212:215], v1, s[8:11], s16 offen offset:1024 nt
    s_mov_b32 s16, s13
    v_add_u32 v72, 512, v72
    s_add_u32 s21, s21, 1
    s_cmp_eq_u32 s21, s66
    s_cbranch_scc1 L_kev
    s_cmp_eq_u32 s22, 1
    s_cbranch_scc1 L_k1
    s_cmp_eq_u32 s22, 2
    s_cbranch_scc1 L_k2
    s_cmp_eq_u32 s22, 0
    s_cbranch_scc1 L_k0
    s_branch L_k3
L_pub_k3_0:
    s_mov_b64 exec, s[4:5]
    global_store_byte v73, v75, s[64:65]
    s_mov_b64 exec, -1
    s_add_u32 s3, s3, 32
    s_branch L_pubx_k3_0
L_pub_k3_1:
    s_mov_b64 exec, s[4:5]
    global_store_short v73, v75, s[64:65]
    s_mov_b64 exec, -1
    s_add_u32 s6, s6, 32
    s_lshl_b64 s[4:5], s[4:5], 32
    s_branch L_pubx_k3_1
L_kev:
    s_cmp_eq_u32 s21, 32
    s_cbranch_scc1 L_kdone
    s_cmp_lg_u32 s21, 2
    s_cbranch_scc1 L_late0
    s_lshl_b32 s42, s19, 22
    s_lshl_b32 s44, s19, 8
    s_add_u32 s28, s28, s42
    s_addc_u32 s29, s29, 0
    s_add_u32 s36, s36, s44
    s_addc_u32 s37, s37, 0
    v_lshrrev_b32 v8, 5, v0
    v_lshl_add_u32 v53, v8, 2, v53
    v_lshl_add_u32 v2, v8, 21, v2
    v_bfe_u32 v8, v0, 4, 1
    v_lshl_add_u32 v2, v8, 11, v2
    v_add_u32 v2, s15, v2
    s_mov_b32 s18, 0x3e0293ee
    s_lshr_b32 s42, s19, 5
    s_lshl_b32 s42, s42, 4
    s_waitcnt lgkmcnt(0)
    s_lshr_b32 s48, s48, s42
    s_lshl_b32 s48, s48, 16
    v_sub_f32 v9, s48, 1.0
    v_mul_f32 v9, 0x4eabfb8f, v9
    s_cmp_eq_u32 s20, 0
    s_cselect_b32 s42, 0, 0xff800000
    v_add_f32 v9, s42, v9
    s_mov_b32 s42, 0x200000
    s_load_dword s58, s[28:29], 0
    s_load_dword s59, s[28:29], s42
    s_mov_b32 s66, 4
    s_branch L_kn
L_late0:
    s_cmp_lg_u32 s21, 4
    s_cbranch_scc1 L_late1
    v_and_b32 v7, 1, v0
    v_lshlrev_b32 v7, 4, v7
    v_mov_b32 v8, 0xffff
    v_lshlrev_b32 v8, v7, v8
    v_bfe_u32 v7, v0, 1, 2
    v_cmp_eq_u32 vcc, 0, v7
    v_lshlrev_b32 v28, 16, v24
    v_lshlrev_b32 v29, 16, v25
    v_cndmask_b32 v12, 0, v8, vcc
    v_cmp_eq_u32 vcc, 1, v7
    v_mul_f32 v4, v28, v29
    v_and_b32 v28, 0xffff0000, v24
    v_cndmask_b32 v13, 0, v8, vcc
    v_cmp_eq_u32 vcc, 2, v7
    v_and_b32 v29, 0xffff0000, v25
    v_fmac_f32 v4, v28, v29
    v_cndmask_b32 v14, 0, v8, vcc
    v_cmp_eq_u32 vcc, 3, v7
    v_lshlrev_b32 v24, 16, v86
    v_and_b32 v25, 0xffff0000, v86
    v_cndmask_b32 v15, 0, v8, vcc
    v_lshlrev_b32 v26, 16, v87
    v_and_b32 v27, 0xffff0000, v87
    s_mov_b32 s66, 6
    s_branch L_kn
L_late1:
    s_cmp_lg_u32 s21, 6
    s_cbranch_scc1 L_late2
    v_add_f32_dpp v4, v4, v4 row_ror:1 row_mask:0xf bank_mask:0xf
    v_mov_b32 v28, 0
    s_nop 0
    v_add_f32_dpp v4, v4, v4 row_ror:2 row_mask:0xf bank_mask:0xf
    v_mov_b32 v29, 0
    s_nop 0
    v_add_f32_dpp v4, v4, v4 row_ror:4 row_mask:0xf bank_mask:0xf
    v_mov_b32 v30, 0
    s_nop 0
    v_add_f32_dpp v4, v4, v4 row_ror:8 row_mask:0xf bank_mask:0xf
    v_mov_b32 v31, 0
    v_mov_b32 v7, v4
    s_nop 1
    v_permlane16_swap_b32 v4, v7
    s_nop 1
    v_add_f32 v4, v4, v7
    v_mov_b32 v7, v4
    s_nop 1
    v_permlane32_swap_b32 v4, v7
    s_nop 1
    v_add_f32 v4, v4, v7
    v_fma_f32 v4, v4, s18, v9
    s_mov_b32 s66, 31
    s_branch L_kn
L_late2:
    s_mov_b32 s8, s28
    s_mov_b32 s9, s29
    s_mov_b32 s16, s14
    s_mov_b32 s17, 0
    v_mov_b32 v1, v2
    s_mov_b32 s66, 32
    v_and_b32 v8, 3, v0
    v_and_b32 v7, 60, v0
    v_lshl_add_u32 v8, v8, 6, v7
    v_add_u32 v8, 64, v8
    s_max_u32 s22, s22, 2
L_kn:
    s_cmp_eq_u32 s22, 0
    s_cbranch_scc1 L_k0
    s_cmp_eq_u32 s22, 1
    s_cbranch_scc1 L_k1
    s_cmp_eq_u32 s22, 2
    s_cbranch_scc1 L_k2
    s_branch L_k3
L_kdone:
    ds_read_b32 v48, v8
    ds_read_b32 v49, v8 offset:256
    v_mov_b32_dpp v5, v20 quad_perm:[0,0,0,0] row_mask:0xf bank_mask:0xf
    v_mov_b32_dpp v6, v22 quad_perm:[2,2,2,2] row_mask:0xf bank_mask:0xf
    s_mov_b32 s66, 63
    v_add_f32_dpp v5, v21, v5 quad_perm:[1,1,1,1] row_mask:0xf bank_mask:0xf
    v_add_f32_dpp v6, v23, v6 quad_perm:[3,3,3,3] row_mask:0xf bank_mask:0xf
    v_add_f32 v5, v5, v6
    v_max_f32 v10, v10, v5
    ds_write_b32 v72, v5 offset:0
    v_mov_b32 v72, v8
    v_max_f32_dpp v10, v10, v10 row_ror:4 row_mask:0xf bank_mask:0xf
    s_nop 1
    v_max_f32_dpp v10, v10, v10 row_ror:8 row_mask:0xf bank_mask:0xf
    v_mov_b32 v5, v10
    s_nop 1
    v_permlane16_swap_b32 v10, v5
    s_nop 1
    v_max_f32 v10, v10, v5
    v_mov_b32 v5, v10
    s_nop 1
    v_permlane32_swap_b32 v10, v5
    s_nop 1
    v_max_f32 v10, v10, v5
    v_mul_f32 v11, s18, v10
    v_max_f32 v11, v11, v4
    v_and_b32 v11, -2, v11
    s_waitcnt lgkmcnt(0)
    v_sub_f32 v4, v4, v11
    v_exp_f32 v4, v4
    v_fma_f32 v7, v48, s18, -v11
    v_exp_f32 v7, v7
    v_mul_f32 v9, 0x3c800000, v4
    v_cvt_pk_bf16_f32 v80, v7, v7
    v_add_f32 v9, v9, v7
    v_mov_b32 v48, v49
    v_mov_b32_dpp v81, v80 row_ror:4 row_mask:0xf bank_mask:0xf
    v_mov_b32_dpp v82, v80 row_ror:12 row_mask:0xf bank_mask:0xf
    v_mul_f32 v24, v24, v4
    v_mul_f32 v25, v25, v4
    v_mul_f32 v26, v26, v4
    v_mul_f32 v27, v27, v4
    v_and_b32_dpp v16, v80, v12 quad_perm:[0,0,0,0] row_mask:0xf bank_mask:0xf
    v_and_b32_dpp v17, v80, v13 quad_perm:[0,0,0,0] row_mask:0xf bank_mask:0xf
    v_and_b32_dpp v18, v81, v14 quad_perm:[0,0,0,0] row_mask:0xf bank_mask:0xf
    v_and_b32_dpp v19, v81, v15 quad_perm:[0,0,0,0] row_mask:0xf bank_mask:0xf
    s_cmp_eq_u32 s22, 0
    s_cbranch_scc1 L_v0
    s_cmp_eq_u32 s22, 1
    s_cbranch_scc1 L_v1
    s_cmp_eq_u32 s22, 2
    s_cbranch_scc1 L_v2
    s_branch L_v3
L_v0:
    v_mfma_f32_16x16x32_bf16 v[24:27], v[16:19], v[88:91], v[24:27]
    s_waitcnt vmcnt(19)
    buffer_load_dwordx4 v[88:91], v1, s[8:11], s16 offen offset:0 nt
    s_xor_b32 s16, s16, s68
    v_and_b32_dpp v20, v82, v12 quad_perm:[0,0,0,0] row_mask:0xf bank_mask:0xf
    v_and_b32_dpp v21, v82, v13 quad_perm:[0,0,0,0] row_mask:0xf bank_mask:0xf
    v_and_b32_dpp v22, v80, v14 quad_perm:[0,0,0,0] row_mask:0xf bank_mask:0xf
    v_and_b32_dpp v23, v80, v15 quad_perm:[0,0,0,0] row_mask:0xf bank_mask:0xf
    v_mfma_f32_16x16x32_bf16 v[28:31], v[16:19], v[92:95], v[28:31]
    s_waitcnt vmcnt(19) lgkmcnt(0)
    buffer_load_dwordx4 v[92:95], v1, s[8:11], s16 offen offset:0 nt
    s_xor_b32 s16, s16, s69
    v_fma_f32 v7, v48, s18, -v11
    v_exp_f32 v7, v7
    ds_read_b32 v48, v72 offset:512
    v_mfma_f32_16x16x32_bf16 v[24:27], v[20:23], v[96:99], v[24:27]
    s_waitcnt vmcnt(19)
    buffer_load_dwordx4 v[96:99], v1, s[8:11], s16 offen offset:0 nt
    s_xor_b32 s16, s16, s68
    v_and_b32_dpp v16, v80, v12 quad_perm:[1,1,1,1] row_mask:0xf bank_mask:0xf
    v_and_b32_dpp v17, v80, v13 quad_perm:[1,1,1,1] row_mask:0xf bank_mask:0xf
    v_and_b32_dpp v18, v81, v14 quad_perm:[1,1,1,1] row_mask:0xf bank_mask:0xf
    v_and_b32_dpp v19, v81, v15 quad_perm:[1,1,1,1] row_mask:0xf bank_mask:0xf
    v_mfma_f32_16x16x32_bf16 v[28:31], v[20:23], v[100:103], v[28:31]
    s_waitcnt vmcnt(19)
    buffer_load_dwordx4 v[100:103], v1, s[8:11], s16 offen offset:0 nt
    s_xor_b32 s16, s16, s70
    v_cvt_pk_bf16_f32 v83, v7, v7
    v_add_f32 v9, v9, v7
    v_mfma_f32_16x16x32_bf16 v[24:27], v[16:19], v[104:107], v[24:27]
    s_waitcnt vmcnt(19)
    buffer_load_dwordx4 v[104:107], v1, s[8:11], s16 offen offset:0 nt
    s_xor_b32 s16, s16, s68
    v_and_b32_dpp v20, v82, v12 quad_perm:[1,1,1,1] row_mask:0xf bank_mask:0xf
    v_and_b32_dpp v21, v82, v13 quad_perm:[1,1,1,1] row_mask:0xf bank_mask:0xf
    v_and_b32_dpp v22, v80, v14 quad_perm:[1,1,1,1] row_mask:0xf bank_mask:0xf
    v_and_b32_dpp v23, v80, v15 quad_perm:[1,1,1,1] row_mask:0xf bank_mask:0xf
    v_mfma_f32_16x16x32_bf16 v[28:31], v[16:19], v[108:111], v[28:31]
    s_waitcnt vmcnt(19)
    buffer_load_dwordx4 v[108:111], v1, s[8:11], s16 offen offset:0 nt
    s_xor_b32 s16, s16, s69
    s_cmp_eq_u32 s21, s3
    s_cbranch_scc1 L_pub_v0_0
L_pubx_v0_0:
    global_load_dword v54, v73, s[64:65] sc1
    v_mov_b32_dpp v84, v83 row_ror:4 row_mask:0xf bank_mask:0xf
    v_mov_b32_dpp v85, v83 row_ror:12 row_mask:0xf bank_mask:0xf
    v_mfma_f32_16x16x32_bf16 v[24:27], v[20:23], v[112:115], v[24:27]
    s_waitcnt vmcnt(20)
    buffer_load_dwordx4 v[112:115], v1, s[8:11], s16 offen offset:0 nt
    s_xor_b32 s16, s16, s68
    v_and_b32_dpp v16, v80, v12 quad_perm:[2,2,2,2] row_mask:0xf bank_mask:0xf
    v_and_b32_dpp v17, v80, v13 quad_perm:[2,2,2,2] row_mask:0xf bank_mask:0xf
    v_and_b32_dpp v18, v81, v14 quad_perm:[2,2,2,2] row_mask:0xf bank_mask:0xf
    v_and_b32_dpp v19, v81, v15 quad_perm:[2,2,2,2] row_mask:0xf bank_mask:0xf
    v_mfma_f32_16x16x32_bf16 v[28:31], v[20:23], v[116:119], v[28:31]
    s_waitcnt vmcnt(20)
    buffer_load_dwordx4 v[116:119], v1, s[8:11], s16 offen offset:0 nt
    s_xor_b32 s16, s16, s71
    v_mfma_f32_16x16x32_bf16 v[24:27], v[16:19], v[120:123], v[24:27]
    s_waitcnt vmcnt(20)
    buffer_load_dwordx4 v[120:123], v1, s[8:11], s16 offen offset:0 nt
    s_xor_b32 s16, s16, s68
    s_add_u32 s17, s17, 1
    s_bfe_u32 s12, s17, 0x10000
    s_lshl_b32 s12, s12, 17
    s_xor_b32 s13, s14, s12
    v_and_b32_dpp v20, v82, v12 quad_perm:[2,2,2,2] row_mask:0xf bank_mask:0xf
    v_and_b32_dpp v21, v82, v13 quad_perm:[2,2,2,2] row_mask:0xf bank_mask:0xf
    v_and_b32_dpp v22, v80, v14 quad_perm:[2,2,2,2] row_mask:0xf bank_mask:0xf
    v_and_b32_dpp v23, v80, v15 quad_perm:[2,2,2,2] row_mask:0xf bank_mask:0xf
    v_mfma_f32_16x16x32_bf16 v[28:31], v[16:19], v[124:127], v[28:31]
    s_waitcnt vmcnt(20)
    buffer_load_dwordx4 v[124:127], v1, s[8:11], s16 offen offset:0 nt
    s_xor_b32 s16, s16, s69
    s_bfe_u32 s12, s17, 0x10001
    s_lshl_b32 s12, s12, 9
    s_xor_b32 s13, s13, s12
    v_mfma_f32_16x16x32_bf16 v[24:27], v[20:23], v[128:131], v[24:27]
    s_waitcnt vmcnt(20)
    buffer_load_dwordx4 v[128:131], v1, s[8:11], s16 offen offset:0 nt
    s_xor_b32 s16, s16, s68
    s_bfe_u32 s12, s17, 0x30002
    s_lshl_b32 s12, s12, 18
    s_xor_b32 s13, s13, s12
    v_and_b32_dpp v16, v80, v12 quad_perm:[3,3,3,3] row_mask:0xf bank_mask:0xf
    v_and_b32_dpp v17, v80, v13 quad_perm:[3,3,3,3] row_mask:0xf bank_mask:0xf
    v_and_b32_dpp v18, v81, v14 quad_perm:[3,3,3,3] row_mask:0xf bank_mask:0xf
    v_and_b32_dpp v19, v81, v15 quad_perm:[3,3,3,3] row_mask:0xf bank_mask:0xf
    v_mfma_f32_16x16x32_bf16 v[28:31], v[20:23], v[132:135], v[28:31]
    s_waitcnt vmcnt(20)
    buffer_load_dwordx4 v[132:135], v1, s[8:11], s16 offen offset:0 nt
    s_xor_b32 s16, s16, s70
    v_mfma_f32_16x16x32_bf16 v[24:27], v[16:19], v[136:139], v[24:27]
    s_waitcnt vmcnt(20)
    buffer_load_dwordx4 v[136:139], v1, s[8:11], s16 offen offset:0 nt
    s_xor_b32 s16, s16, s68
    v_and_b32_dpp v20, v82, v12 quad_perm:[3,3,3,3] row_mask:0xf bank_mask:0xf
    v_and_b32_dpp v21, v82, v13 quad_perm:[3,3,3,3] row_mask:0xf bank_mask:0xf
    v_and_b32_dpp v22, v80, v14 quad_perm:[3,3,3,3] row_mask:0xf bank_mask:0xf
    v_and_b32_dpp v23, v80, v15 quad_perm:[3,3,3,3] row_mask:0xf bank_mask:0xf
    v_mfma_f32_16x16x32_bf16 v[28:31], v[16:19], v[140:143], v[28:31]
    s_waitcnt vmcnt(20)
    buffer_load_dwordx4 v[140:143], v1, s[8:11], s16 offen offset:0 nt
    s_xor_b32 s16, s16, s69
    v_mfma_f32_16x16x32_bf16 v[24:27], v[20:23], v[144:147], v[24:27]
    s_waitcnt vmcnt(20)
    buffer_load_dwordx4 v[144:147], v1, s[8:11], s16 offen offset:0 nt
    s_xor_b32 s16, s16, s68
    v_and_b32_dpp v16, v83, v12 quad_perm:[0,0,0,0] row_mask:0xf bank_mask:0xf
    v_and_b32_dpp v17, v83, v13 quad_perm:[0,0,0,0] row_mask:0xf bank_mask:0xf
    v_and_b32_dpp v18, v84, v14 quad_perm:[0,0,0,0] row_mask:0xf bank_mask:0xf
    v_and_b32_dpp v19, v84, v15 quad_perm:[0,0,0,0] row_mask:0xf bank_mask:0xf
    v_mfma_f32_16x16x32_bf16 v[28:31], v[20:23], v[148:151], v[28:31]
    s_waitcnt vmcnt(20)
    buffer_load_dwordx4 v[148:151], v1, s[8:11], s16 offen offset:0 nt
    s_xor_b32 s16, s16, s71
    v_mfma_f32_16x16x32_bf16 v[24:27], v[16:19], v[152:155], v[24:27]
    s_waitcnt vmcnt(20)
    buffer_load_dwordx4 v[152:155], v1, s[8:11], s16 offen offset:1024 nt
    s_xor_b32 s16, s16, s68
    v_and_b32_dpp v20, v85, v12 quad_perm:[0,0,0,0] row_mask:0xf bank_mask:0xf
    v_and_b32_dpp v21, v85, v13 quad_perm:[0,0,0,0] row_mask:0xf bank_mask:0xf
    v_and_b32_dpp v22, v83, v14 quad_perm:[0,0,0,0] row_mask:0xf bank_mask:0xf
    v_and_b32_dpp v23, v83, v15 quad_perm:[0,0,0,0] row_mask:0xf bank_mask:0xf
    v_mfma_f32_16x16x32_bf16 v[28:31], v[16:19], v[156:159], v[28:31]
    s_waitcnt vmcnt(20) lgkmcnt(0)
    buffer_load_dwordx4 v[156:159], v1, s[8:11], s16 offen offset:1024 nt
    s_xor_b32 s16, s16, s69
    v_fma_f32 v7, v48, s18, -v11
    v_exp_f32 v7, v7
    ds_read_b32 v48, v72 offset:768
    v_mfma_f32_16x16x32_bf16 v[24:27], v[20:23], v[160:163], v[24:27]
    s_waitcnt vmcnt(20)
    buffer_load_dwordx4 v[160:163], v1, s[8:11], s16 offen offset:1024 nt
    s_xor_b32 s16, s16, s68
    v_and_b32_dpp v16, v83, v12 quad_perm:[1,1,1,1] row_mask:0xf bank_mask:0xf
    v_and_b32_dpp v17, v83, v13 quad_perm:[1,1,1,1] row_mask:0xf bank_mask:0xf
    v_and_b32_dpp v18, v84, v14 quad_perm:[1,1,1,1] row_mask:0xf bank_mask:0xf
    v_and_b32_dpp v19, v84, v15 quad_perm:[1,1,1,1] row_mask:0xf bank_mask:0xf
    v_mfma_f32_16x16x32_bf16 v[28:31], v[20:23], v[164:167], v[28:31]
    s_waitcnt vmcnt(20)
    buffer_load_dwordx4 v[164:167], v1, s[8:11], s16 offen offset:1024 nt
    s_xor_b32 s16, s16, s70
    v_cvt_pk_bf16_f32 v80, v7, v7
    v_add_f32 v9, v9, v7
    v_mfma_f32_16x16x32_bf16 v[24:27], v[16:19], v[168:171], v[24:27]
    s_waitcnt vmcnt(20)
    buffer_load_dwordx4 v[168:171], v1, s[8:11], s16 offen offset:1024 nt
    s_xor_b32 s16, s16, s68
    v_and_b32_dpp v20, v85, v12 quad_perm:[1,1,1,1] row_mask:0xf bank_mask:0xf
    v_and_b32_dpp v21, v85, v13 quad_perm:[1,1,1,1] row_mask:0xf bank_mask:0xf
    v_and_b32_dpp v22, v83, v14 quad_perm:[1,1,1,1] row_mask:0xf bank_mask:0xf
    v_and_b32_dpp v23, v83, v15 quad_perm:[1,1,1,1] row_mask:0xf bank_mask:0xf
    v_mfma_f32_16x16x32_bf16 v[28:31], v[16:19], v[172:175], v[28:31]
    s_waitcnt vmcnt(20)
    buffer_load_dwordx4 v[172:175], v1, s[8:11], s16 offen offset:1024 nt
    s_xor_b32 s16, s16, s69
    v_mov_b32_dpp v81, v80 row_ror:4 row_mask:0xf bank_mask:0xf
    v_mov_b32_dpp v82, v80 row_ror:12 row_mask:0xf bank_mask:0xf
    v_mfma_f32_16x16x32_bf16 v[24:27], v[20:23], v[176:179], v[24:27]
    s_waitcnt vmcnt(20)
    buffer_load_dwordx4 v[176:179], v1, s[8:11], s16 offen offset:1024 nt
    s_xor_b32 s16, s16, s68
    v_and_b32_dpp v16, v83, v12 quad_perm:[2,2,2,2] row_mask:0xf bank_mask:0xf
    v_and_b32_dpp v17, v83, v13 quad_perm:[2,2,2,2] row_mask:0xf bank_mask:0xf
    v_and_b32_dpp v18, v84, v14 quad_perm:[2,2,2,2] row_mask:0xf bank_mask:0xf
    v_and_b32_dpp v19, v84, v15 quad_perm:[2,2,2,2] row_mask:0xf bank_mask:0xf
    v_mfma_f32_16x16x32_bf16 v[28:31], v[20:23], v[180:183], v[28:31]
    s_waitcnt vmcnt(20)
    buffer_load_dwordx4 v[180:183], v1, s[8:11], s16 offen offset:1024 nt
    s_xor_b32 s16, s16, s71
    v_mfma_f32_16x16x32_bf16 v[24:27], v[16:19], v[184:187], v[24:27]
    s_waitcnt vmcnt(20)
    buffer_load_dwordx4 v[184:187], v1, s[8:11], s16 offen offset:1024 nt
    s_xor_b32 s16, s16, s68
    v_and_b32_dpp v20, v85, v12 quad_perm:[2,2,2,2] row_mask:0xf bank_mask:0xf
    v_and_b32_dpp v21, v85, v13 quad_perm:[2,2,2,2] row_mask:0xf bank_mask:0xf
    v_and_b32_dpp v22, v83, v14 quad_perm:[2,2,2,2] row_mask:0xf bank_mask:0xf
    v_and_b32_dpp v23, v83, v15 quad_perm:[2,2,2,2] row_mask:0xf bank_mask:0xf
    v_mfma_f32_16x16x32_bf16 v[28:31], v[16:19], v[188:191], v[28:31]
    s_waitcnt vmcnt(19)
    buffer_load_dwordx4 v[188:191], v1, s[8:11], s16 offen offset:1024 nt
    s_xor_b32 s16, s16, s69
    s_cmp_eq_u32 s21, s6
    s_cbranch_scc1 L_pub_v0_1
L_pubx_v0_1:
    v_mfma_f32_16x16x32_bf16 v[24:27], v[20:23], v[192:195], v[24:27]
    s_waitcnt vmcnt(19)
    buffer_load_dwordx4 v[192:195], v1, s[8:11], s16 offen offset:1024 nt
    s_xor_b32 s16, s16, s68
    v_and_b32_dpp v16, v83, v12 quad_perm:[3,3,3,3] row_mask:0xf bank_mask:0xf
    v_and_b32_dpp v17, v83, v13 quad_perm:[3,3,3,3] row_mask:0xf bank_mask:0xf
    v_and_b32_dpp v18, v84, v14 quad_perm:[3,3,3,3] row_mask:0xf bank_mask:0xf
    v_and_b32_dpp v19, v84, v15 quad_perm:[3,3,3,3] row_mask:0xf bank_mask:0xf
    v_mfma_f32_16x16x32_bf16 v[28:31], v[20:23], v[196:199], v[28:31]
    s_waitcnt vmcnt(19)
    buffer_load_dwordx4 v[196:199], v1, s[8:11], s16 offen offset:1024 nt
    s_xor_b32 s16, s16, s70
    v_readlane_b32 s42, v74, s21
    s_add_u32 s49, s49, s50
    s_lshr_b32 s22, s49, 4
    s_and_b32 s49, s49, 15
    v_mfma_f32_16x16x32_bf16 v[24:27], v[16:19], v[200:203], v[24:27]
    s_waitcnt vmcnt(19)
    buffer_load_dwordx4 v[200:203], v1, s[8:11], s16 offen offset:1024 nt
    s_xor_b32 s16, s16, s68
    v_and_b32_dpp v20, v85, v12 quad_perm:[3,3,3,3] row_mask:0xf bank_mask:0xf
    v_and_b32_dpp v21, v85, v13 quad_perm:[3,3,3,3] row_mask:0xf bank_mask:0xf
    v_and_b32_dpp v22, v83, v14 quad_perm:[3,3,3,3] row_mask:0xf bank_mask:0xf
    v_and_b32_dpp v23, v83, v15 quad_perm:[3,3,3,3] row_mask:0xf bank_mask:0xf
    v_mfma_f32_16x16x32_bf16 v[28:31], v[16:19], v[204:207], v[28:31]
    s_waitcnt vmcnt(19)
    buffer_load_dwordx4 v[204:207], v1, s[8:11], s16 offen offset:1024 nt
    s_xor_b32 s16, s16, s69
    v_readlane_b32 s23, v54, s21
    v_mfma_f32_16x16x32_bf16 v[24:27], v[20:23], v[208:211], v[24:27]
    s_waitcnt vmcnt(19)
    buffer_load_dwordx4 v[208:211], v1, s[8:11], s16 offen offset:1024 nt
    s_xor_b32 s16, s16, s68
    s_xor_b32 s42, s42, s23
    s_bcnt1_i32_b32 s42, s42
    s_lshr_b32 s42, 0x90100, s42
    s_and_b32 s42, s42, 15
    s_add_u32 s22, s22, s42
    v_and_b32_dpp v16, v80, v12 quad_perm:[0,0,0,0] row_mask:0xf bank_mask:0xf
    v_and_b32_dpp v17, v80, v13 quad_perm:[0,0,0,0] row_mask:0xf bank_mask:0xf
    v_and_b32_dpp v18, v81, v14 quad_perm:[0,0,0,0] row_mask:0xf bank_mask:0xf
    v_and_b32_dpp v19, v81, v15 quad_perm:[0,0,0,0] row_mask:0xf bank_mask:0xf
    v_mfma_f32_16x16x32_bf16 v[28:31], v[20:23], v[212:215], v[28:31]
    s_waitcnt vmcnt(19)
    buffer_load_dwordx4 v[212:215], v1, s[8:11], s16 offen offset:1024 nt
    s_mov_b32 s16, s13
    v_add_u32 v72, 512, v72
    s_add_u32 s21, s21, 1
    s_cmp_eq_u32 s21, s66
    s_cbranch_scc1 L_vev
    s_cmp_eq_u32 s22, 1
    s_cbranch_scc1 L_v1
    s_cmp_eq_u32 s22, 2
    s_cbranch_scc1 L_v2
    s_cmp_eq_u32 s22, 0
    s_cbranch_scc1 L_v0
    s_branch L_v3
L_pub_v0_0:
    s_mov_b64 exec, s[4:5]
    global_store_byte v73, v75, s[64:65]
    s_mov_b64 exec, -1
    s_add_u32 s3, s3, 32
    s_branch L_pubx_v0_0
L_pub_v0_1:
    s_mov_b64 exec, s[4:5]
    global_store_short v73, v75, s[64:65]
    s_mov_b64 exec, -1
    s_add_u32 s6, s6, 32
    s_lshl_b64 s[4:5], s[4:5], 32
    s_branch L_pubx_v0_1
L_v1:
    v_mfma_f32_16x16x32_bf16 v[24:27], v[16:19], v[88:91], v[24:27]
    s_waitcnt vmcnt(20)
    buffer_load_dwordx4 v[88:91], v1, s[8:11], s16 offen offset:0 nt
    s_xor_b32 s16, s16, s68
    v_and_b32_dpp v20, v82, v12 quad_perm:[0,0,0,0] row_mask:0xf bank_mask:0xf
    v_and_b32_dpp v21, v82, v13 quad_perm:[0,0,0,0] row_mask:0xf bank_mask:0xf
    v_and_b32_dpp v22, v80, v14 quad_perm:[0,0,0,0] row_mask:0xf bank_mask:0xf
    v_and_b32_dpp v23, v80, v15 quad_perm:[0,0,0,0] row_mask:0xf bank_mask:0xf
    v_mfma_f32_16x16x32_bf16 v[28:31], v[16:19], v[92:95], v[28:31]
    s_waitcnt vmcnt(20) lgkmcnt(0)
    buffer_load_dwordx4 v[92:95], v1, s[8:11], s16 offen offset:0 nt
    s_xor_b32 s16, s16, s69
    v_fma_f32 v7, v48, s18, -v11
    v_exp_f32 v7, v7
    ds_read_b32 v48, v72 offset:512
    v_mfma_f32_16x16x32_bf16 v[24:27], v[20:23], v[96:99], v[24:27]
    s_waitcnt vmcnt(20)
    buffer_load_dwordx4 v[96:99], v1, s[8:11], s16 offen offset:0 nt
    s_xor_b32 s16, s16, s68
    v_and_b32_dpp v16, v80, v12 quad_perm:[1,1,1,1] row_mask:0xf bank_mask:0xf
    v_and_b32_dpp v17, v80, v13 quad_perm:[1,1,1,1] row_mask:0xf bank_mask:0xf
    v_and_b32_dpp v18, v81, v14 quad_perm:[1,1,1,1] row_mask:0xf bank_mask:0xf
    v_and_b32_dpp v19, v81, v15 quad_perm:[1,1,1,1] row_mask:0xf bank_mask:0xf
    v_mfma_f32_16x16x32_bf16 v[28:31], v[20:23], v[100:103], v[28:31]
    s_waitcnt vmcnt(20)
    buffer_load_dwordx4 v[100:103], v1, s[8:11], s16 offen offset:0 nt
    s_xor_b32 s16, s16, s70
    v_cvt_pk_bf16_f32 v83, v7, v7
    v_add_f32 v9, v9, v7
    v_mfma_f32_16x16x32_bf16 v[24:27], v[16:19], v[104:107], v[24:27]
    s_waitcnt vmcnt(20)
    buffer_load_dwordx4 v[104:107], v1, s[8:11], s16 offen offset:0 nt
    s_xor_b32 s16, s16, s68
    v_and_b32_dpp v20, v82, v12 quad_perm:[1,1,1,1] row_mask:0xf bank_mask:0xf
    v_and_b32_dpp v21, v82, v13 quad_perm:[1,1,1,1] row_mask:0xf bank_mask:0xf
    v_and_b32_dpp v22, v80, v14 quad_perm:[1,1,1,1] row_mask:0xf bank_mask:0xf
    v_and_b32_dpp v23, v80, v15 quad_perm:[1,1,1,1] row_mask:0xf bank_mask:0xf
    v_mfma_f32_16x16x32_bf16 v[28:31], v[16:19], v[108:111], v[28:31]
    s_waitcnt vmcnt(20)
    buffer_load_dwordx4 v[108:111], v1, s[8:11], s16 offen offset:0 nt
    s_xor_b32 s16, s16, s69
    s_cmp_eq_u32 s21, s3
    s_cbranch_scc1 L_pub_v1_0
L_pubx_v1_0:
    global_load_dword v54, v73, s[64:65] sc1
    v_mov_b32_dpp v84, v83 row_ror:4 row_mask:0xf bank_mask:0xf
    v_mov_b32_dpp v85, v83 row_ror:12 row_mask:0xf bank_mask:0xf
    v_mfma_f32_16x16x32_bf16 v[24:27], v[20:23], v[112:115], v[24:27]
    s_waitcnt vmcnt(21)
    buffer_load_dwordx4 v[112:115], v1, s[8:11], s16 offen offset:0 nt
    s_xor_b32 s16, s16, s68
    v_and_b32_dpp v16, v80, v12 quad_perm:[2,2,2,2] row_mask:0xf bank_mask:0xf
    v_and_b32_dpp v17, v80, v13 quad_perm:[2,2,2,2] row_mask:0xf bank_mask:0xf
    v_and_b32_dpp v18, v81, v14 quad_perm:[2,2,2,2] row_mask:0xf bank_mask:0xf
    v_and_b32_dpp v19, v81, v15 quad_perm:[2,2,2,2] row_mask:0xf bank_mask:0xf
    v_mfma_f32_16x16x32_bf16 v[28:31], v[20:23], v[116:119], v[28:31]
    s_waitcnt vmcnt(21)
    buffer_load_dwordx4 v[116:119], v1, s[8:11], s16 offen offset:0 nt
    s_xor_b32 s16, s16, s71
    v_mfma_f32_16x16x32_bf16 v[24:27], v[16:19], v[120:123], v[24:27]
    s_waitcnt vmcnt(21)
    buffer_load_dwordx4 v[120:123], v1, s[8:11], s16 offen offset:0 nt
    s_xor_b32 s16, s16, s68
    s_add_u32 s17, s17, 1
    s_bfe_u32 s12, s17, 0x10000
    s_lshl_b32 s12, s12, 17
    s_xor_b32 s13, s14, s12
    v_and_b32_dpp v20, v82, v12 quad_perm:[2,2,2,2] row_mask:0xf bank_mask:0xf
    v_and_b32_dpp v21, v82, v13 quad_perm:[2,2,2,2] row_mask:0xf bank_mask:0xf
    v_and_b32_dpp v22, v80, v14 quad_perm:[2,2,2,2] row_mask:0xf bank_mask:0xf
    v_and_b32_dpp v23, v80, v15 quad_perm:[2,2,2,2] row_mask:0xf bank_mask:0xf
    v_mfma_f32_16x16x32_bf16 v[28:31], v[16:19], v[124:127], v[28:31]
    s_waitcnt vmcnt(21)
    buffer_load_dwordx4 v[124:127], v1, s[8:11], s16 offen offset:0 nt
    s_xor_b32 s16, s16, s69
    s_bfe_u32 s12, s17, 0x10001
    s_lshl_b32 s12, s12, 9
    s_xor_b32 s13, s13, s12
    v_mfma_f32_16x16x32_bf16 v[24:27], v[20:23], v[128:131], v[24:27]
    s_waitcnt vmcnt(21)
    buffer_load_dwordx4 v[128:131], v1, s[8:11], s16 offen offset:0 nt
    s_xor_b32 s16, s16, s68
    s_bfe_u32 s12, s17, 0x30002
    s_lshl_b32 s12, s12, 18
    s_xor_b32 s13, s13, s12
    v_and_b32_dpp v16, v80, v12 quad_perm:[3,3,3,3] row_mask:0xf bank_mask:0xf
    v_and_b32_dpp v17, v80, v13 quad_perm:[3,3,3,3] row_mask:0xf bank_mask:0xf
    v_and_b32_dpp v18, v81, v14 quad_perm:[3,3,3,3] row_mask:0xf bank_mask:0xf
    v_and_b32_dpp v19, v81, v15 quad_perm:[3,3,3,3] row_mask:0xf bank_mask:0xf
    v_mfma_f32_16x16x32_bf16 v[28:31], v[20:23], v[132:135], v[28:31]
    s_waitcnt vmcnt(21)
    buffer_load_dwordx4 v[132:135], v1, s[8:11], s16 offen offset:0 nt
    s_xor_b32 s16, s16, s70
    v_mfma_f32_16x16x32_bf16 v[24:27], v[16:19], v[136:139], v[24:27]
    s_waitcnt vmcnt(21)
    buffer_load_dwordx4 v[136:139], v1, s[8:11], s16 offen offset:0 nt
    s_xor_b32 s16, s16, s68
    v_and_b32_dpp v20, v82, v12 quad_perm:[3,3,3,3] row_mask:0xf bank_mask:0xf
    v_and_b32_dpp v21, v82, v13 quad_perm:[3,3,3,3] row_mask:0xf bank_mask:0xf
    v_and_b32_dpp v22, v80, v14 quad_perm:[3,3,3,3] row_mask:0xf bank_mask:0xf
    v_and_b32_dpp v23, v80, v15 quad_perm:[3,3,3,3] row_mask:0xf bank_mask:0xf
    v_mfma_f32_16x16x32_bf16 v[28:31], v[16:19], v[140:143], v[28:31]
    s_waitcnt vmcnt(21)
    buffer_load_dwordx4 v[140:143], v1, s[8:11], s16 offen offset:0 nt
    s_xor_b32 s16, s16, s69
    v_mfma_f32_16x16x32_bf16 v[24:27], v[20:23], v[144:147], v[24:27]
    s_waitcnt vmcnt(21)
    buffer_load_dwordx4 v[144:147], v1, s[8:11], s16 offen offset:0 nt
    s_xor_b32 s16, s16, s68
    v_and_b32_dpp v16, v83, v12 quad_perm:[0,0,0,0] row_mask:0xf bank_mask:0xf
    v_and_b32_dpp v17, v83, v13 quad_perm:[0,0,0,0] row_mask:0xf bank_mask:0xf
    v_and_b32_dpp v18, v84, v14 quad_perm:[0,0,0,0] row_mask:0xf bank_mask:0xf
    v_and_b32_dpp v19, v84, v15 quad_perm:[0,0,0,0] row_mask:0xf bank_mask:0xf
    v_mfma_f32_16x16x32_bf16 v[28:31], v[20:23], v[148:151], v[28:31]
    s_waitcnt vmcnt(21)
    buffer_load_dwordx4 v[148:151], v1, s[8:11], s16 offen offset:0 nt
    s_xor_b32 s16, s16, s71
    v_mfma_f32_16x16x32_bf16 v[24:27], v[16:19], v[152:155], v[24:27]
    s_waitcnt vmcnt(21)
    buffer_load_dwordx4 v[152:155], v1, s[8:11], s16 offen offset:1024 nt
    s_xor_b32 s16, s16, s68
    v_and_b32_dpp v20, v85, v12 quad_perm:[0,0,0,0] row_mask:0xf bank_mask:0xf
    v_and_b32_dpp v21, v85, v13 quad_perm:[0,0,0,0] row_mask:0xf bank_mask:0xf
    v_and_b32_dpp v22, v83, v14 quad_perm:[0,0,0,0] row_mask:0xf bank_mask:0xf
    v_and_b32_dpp v23, v83, v15 quad_perm:[0,0,0,0] row_mask:0xf bank_mask:0xf
    v_mfma_f32_16x16x32_bf16 v[28:31], v[16:19], v[156:159], v[28:31]
    s_waitcnt vmcnt(21) lgkmcnt(0)
    buffer_load_dwordx4 v[156:159], v1, s[8:11], s16 offen offset:1024 nt
    s_xor_b32 s16, s16, s69
    v_fma_f32 v7, v48, s18, -v11
    v_exp_f32 v7, v7
    ds_read_b32 v48, v72 offset:768
    v_mfma_f32_16x16x32_bf16 v[24:27], v[20:23], v[160:163], v[24:27]
    s_waitcnt vmcnt(21)
    buffer_load_dwordx4 v[160:163], v1, s[8:11], s16 offen offset:1024 nt
    s_xor_b32 s16, s16, s68
    v_and_b32_dpp v16, v83, v12 quad_perm:[1,1,1,1] row_mask:0xf bank_mask:0xf
    v_and_b32_dpp v17, v83, v13 quad_perm:[1,1,1,1] row_mask:0xf bank_mask:0xf
    v_and_b32_dpp v18, v84, v14 quad_perm:[1,1,1,1] row_mask:0xf bank_mask:0xf
    v_and_b32_dpp v19, v84, v15 quad_perm:[1,1,1,1] row_mask:0xf bank_mask:0xf
    v_mfma_f32_16x16x32_bf16 v[28:31], v[20:23], v[164:167], v[28:31]
    s_waitcnt vmcnt(21)
    buffer_load_dwordx4 v[164:167], v1, s[8:11], s16 offen offset:1024 nt
    s_xor_b32 s16, s16, s70
    v_cvt_pk_bf16_f32 v80, v7, v7
    v_add_f32 v9, v9, v7
    v_mfma_f32_16x16x32_bf16 v[24:27], v[16:19], v[168:171], v[24:27]
    s_waitcnt vmcnt(21)
    buffer_load_dwordx4 v[168:171], v1, s[8:11], s16 offen offset:1024 nt
    s_xor_b32 s16, s16, s68
    v_and_b32_dpp v20, v85, v12 quad_perm:[1,1,1,1] row_mask:0xf bank_mask:0xf
    v_and_b32_dpp v21, v85, v13 quad_perm:[1,1,1,1] row_mask:0xf bank_mask:0xf
    v_and_b32_dpp v22, v83, v14 quad_perm:[1,1,1,1] row_mask:0xf bank_mask:0xf
    v_and_b32_dpp v23, v83, v15 quad_perm:[1,1,1,1] row_mask:0xf bank_mask:0xf
    v_mfma_f32_16x16x32_bf16 v[28:31], v[16:19], v[172:175], v[28:31]
    s_waitcnt vmcnt(21)
    buffer_load_dwordx4 v[172:175], v1, s[8:11], s16 offen offset:1024 nt
    s_xor_b32 s16, s16, s69
    v_mov_b32_dpp v81, v80 row_ror:4 row_mask:0xf bank_mask:0xf
    v_mov_b32_dpp v82, v80 row_ror:12 row_mask:0xf bank_mask:0xf
    v_mfma_f32_16x16x32_bf16 v[24:27], v[20:23], v[176:179], v[24:27]
    s_waitcnt vmcnt(21)
    buffer_load_dwordx4 v[176:179], v1, s[8:11], s16 offen offset:1024 nt
    s_xor_b32 s16, s16, s68
    v_and_b32_dpp v16, v83, v12 quad_perm:[2,2,2,2] row_mask:0xf bank_mask:0xf
    v_and_b32_dpp v17, v83, v13 quad_perm:[2,2,2,2] row_mask:0xf bank_mask:0xf
    v_and_b32_dpp v18, v84, v14 quad_perm:[2,2,2,2] row_mask:0xf bank_mask:0xf
    v_and_b32_dpp v19, v84, v15 quad_perm:[2,2,2,2] row_mask:0xf bank_mask:0xf
    v_mfma_f32_16x16x32_bf16 v[28:31], v[20:23], v[180:183], v[28:31]
    s_waitcnt vmcnt(21)
    buffer_load_dwordx4 v[180:183], v1, s[8:11], s16 offen offset:1024 nt
    s_xor_b32 s16, s16, s71
    v_mfma_f32_16x16x32_bf16 v[24:27], v[16:19], v[184:187], v[24:27]
    s_waitcnt vmcnt(21)
    buffer_load_dwordx4 v[184:187], v1, s[8:11], s16 offen offset:1024 nt
    s_xor_b32 s16, s16, s68
    v_and_b32_dpp v20, v85, v12 quad_perm:[2,2,2,2] row_mask:0xf bank_mask:0xf
    v_and_b32_dpp v21, v85, v13 quad_perm:[2,2,2,2] row_mask:0xf bank_mask:0xf
    v_and_b32_dpp v22, v83, v14 quad_perm:[2,2,2,2] row_mask:0xf bank_mask:0xf
    v_and_b32_dpp v23, v83, v15 quad_perm:[2,2,2,2] row_mask:0xf bank_mask:0xf
    v_mfma_f32_16x16x32_bf16 v[28:31], v[16:19], v[188:191], v[28:31]
    s_waitcnt vmcnt(21)
    buffer_load_dwordx4 v[188:191], v1, s[8:11], s16 offen offset:1024 nt
    s_xor_b32 s16, s16, s69
    s_cmp_eq_u32 s21, s6
    s_cbranch_scc1 L_pub_v1_1
L_pubx_v1_1:
    v_mfma_f32_16x16x32_bf16 v[24:27], v[20:23], v[192:195], v[24:27]
    s_waitcnt vmcnt(20)
    buffer_load_dwordx4 v[192:195], v1, s[8:11], s16 offen offset:1024 nt
    s_xor_b32 s16, s16, s68
    v_and_b32_dpp v16, v83, v12 quad_perm:[3,3,3,3] row_mask:0xf bank_mask:0xf
    v_and_b32_dpp v17, v83, v13 quad_perm:[3,3,3,3] row_mask:0xf bank_mask:0xf
    v_and_b32_dpp v18, v84, v14 quad_perm:[3,3,3,3] row_mask:0xf bank_mask:0xf
    v_and_b32_dpp v19, v84, v15 quad_perm:[3,3,3,3] row_mask:0xf bank_mask:0xf
    v_mfma_f32_16x16x32_bf16 v[28:31], v[20:23], v[196:199], v[28:31]
    s_waitcnt vmcnt(20)
    buffer_load_dwordx4 v[196:199], v1, s[8:11], s16 offen offset:1024 nt
    s_xor_b32 s16, s16, s70
    v_readlane_b32 s42, v74, s21
    s_add_u32 s49, s49, s50
    s_lshr_b32 s22, s49, 4
    s_and_b32 s49, s49, 15
    v_mfma_f32_16x16x32_bf16 v[24:27], v[16:19], v[200:203], v[24:27]
    s_waitcnt vmcnt(20)
    buffer_load_dwordx4 v[200:203], v1, s[8:11], s16 offen offset:1024 nt
    s_xor_b32 s16, s16, s68
    v_and_b32_dpp v20, v85, v12 quad_perm:[3,3,3,3] row_mask:0xf bank_mask:0xf
    v_and_b32_dpp v21, v85, v13 quad_perm:[3,3,3,3] row_mask:0xf bank_mask:0xf
    v_and_b32_dpp v22, v83, v14 quad_perm:[3,3,3,3] row_mask:0xf bank_mask:0xf
    v_and_b32_dpp v23, v83, v15 quad_perm:[3,3,3,3] row_mask:0xf bank_mask:0xf
    v_mfma_f32_16x16x32_bf16 v[28:31], v[16:19], v[204:207], v[28:31]
    s_waitcnt vmcnt(20)
    buffer_load_dwordx4 v[204:207], v1, s[8:11], s16 offen offset:1024 nt
    s_xor_b32 s16, s16, s69
    v_readlane_b32 s23, v54, s21
    v_mfma_f32_16x16x32_bf16 v[24:27], v[20:23], v[208:211], v[24:27]
    s_waitcnt vmcnt(20)
    buffer_load_dwordx4 v[208:211], v1, s[8:11], s16 offen offset:1024 nt
    s_xor_b32 s16, s16, s68
    s_xor_b32 s42, s42, s23
    s_bcnt1_i32_b32 s42, s42
    s_lshr_b32 s42, 0x90100, s42
    s_and_b32 s42, s42, 15
    s_add_u32 s22, s22, s42
    v_and_b32_dpp v16, v80, v12 quad_perm:[0,0,0,0] row_mask:0xf bank_mask:0xf
    v_and_b32_dpp v17, v80, v13 quad_perm:[0,0,0,0] row_mask:0xf bank_mask:0xf
    v_and_b32_dpp v18, v81, v14 quad_perm:[0,0,0,0] row_mask:0xf bank_mask:0xf
    v_and_b32_dpp v19, v81, v15 quad_perm:[0,0,0,0] row_mask:0xf bank_mask:0xf
    v_mfma_f32_16x16x32_bf16 v[28:31], v[20:23], v[212:215], v[28:31]
    s_waitcnt vmcnt(20)
    buffer_load_dwordx4 v[212:215], v1, s[8:11], s16 offen offset:1024 nt
    s_mov_b32 s16, s13
    v_add_u32 v72, 512, v72
    s_add_u32 s21, s21, 1
    s_cmp_eq_u32 s21, s66
    s_cbranch_scc1 L_vev
    s_cmp_eq_u32 s22, 1
    s_cbranch_scc1 L_v1
    s_cmp_eq_u32 s22, 2
    s_cbranch_scc1 L_v2
    s_cmp_eq_u32 s22, 0
    s_cbranch_scc1 L_v0
    s_branch L_v3
L_pub_v1_0:
    s_mov_b64 exec, s[4:5]
    global_store_byte v73, v75, s[64:65]
    s_mov_b64 exec, -1
    s_add_u32 s3, s3, 32
    s_branch L_pubx_v1_0
L_pub_v1_1:
    s_mov_b64 exec, s[4:5]
    global_store_short v73, v75, s[64:65]
    s_mov_b64 exec, -1
    s_add_u32 s6, s6, 32
    s_lshl_b64 s[4:5], s[4:5], 32
    s_branch L_pubx_v1_1
L_v2:
    v_mfma_f32_16x16x32_bf16 v[24:27], v[16:19], v[88:91], v[24:27]
    s_waitcnt vmcnt(21)
    buffer_load_dwordx4 v[88:91], v1, s[8:11], s16 offen offset:0 nt
    s_xor_b32 s16, s16, s68
    v_and_b32_dpp v20, v82, v12 quad_perm:[0,0,0,0] row_mask:0xf bank_mask:0xf
    v_and_b32_dpp v21, v82, v13 quad_perm:[0,0,0,0] row_mask:0xf bank_mask:0xf
    v_and_b32_dpp v22, v80, v14 quad_perm:[0,0,0,0] row_mask:0xf bank_mask:0xf
    v_and_b32_dpp v23, v80, v15 quad_perm:[0,0,0,0] row_mask:0xf bank_mask:0xf
    v_mfma_f32_16x16x32_bf16 v[28:31], v[16:19], v[92:95], v[28:31]
    s_waitcnt vmcnt(21) lgkmcnt(0)
    buffer_load_dwordx4 v[92:95], v1, s[8:11], s16 offen offset:0 nt
    s_xor_b32 s16, s16, s69
    v_fma_f32 v7, v48, s18, -v11
    v_exp_f32 v7, v7
    ds_read_b32 v48, v72 offset:512
    v_mfma_f32_16x16x32_bf16 v[24:27], v[20:23], v[96:99], v[24:27]
    s_waitcnt vmcnt(21)
    buffer_load_dwordx4 v[96:99], v1, s[8:11], s16 offen offset:0 nt
    s_xor_b32 s16, s16, s68
    v_and_b32_dpp v16, v80, v12 quad_perm:[1,1,1,1] row_mask:0xf bank_mask:0xf
    v_and_b32_dpp v17, v80, v13 quad_perm:[1,1,1,1] row_mask:0xf bank_mask:0xf
    v_and_b32_dpp v18, v81, v14 quad_perm:[1,1,1,1] row_mask:0xf bank_mask:0xf
    v_and_b32_dpp v19, v81, v15 quad_perm:[1,1,1,1] row_mask:0xf bank_mask:0xf
    v_mfma_f32_16x16x32_bf16 v[28:31], v[20:23], v[100:103], v[28:31]
    s_waitcnt vmcnt(21)
    buffer_load_dwordx4 v[100:103], v1, s[8:11], s16 offen offset:0 nt
    s_xor_b32 s16, s16, s70
    v_cvt_pk_bf16_f32 v83, v7, v7
    v_add_f32 v9, v9, v7
    v_mfma_f32_16x16x32_bf16 v[24:27], v[16:19], v[104:107], v[24:27]
    s_waitcnt vmcnt(21)
    buffer_load_dwordx4 v[104:107], v1, s[8:11], s16 offen offset:0 nt
    s_xor_b32 s16, s16, s68
    v_and_b32_dpp v20, v82, v12 quad_perm:[1,1,1,1] row_mask:0xf bank_mask:0xf
    v_and_b32_dpp v21, v82, v13 quad_perm:[1,1,1,1] row_mask:0xf bank_mask:0xf
    v_and_b32_dpp v22, v80, v14 quad_perm:[1,1,1,1] row_mask:0xf bank_mask:0xf
    v_and_b32_dpp v23, v80, v15 quad_perm:[1,1,1,1] row_mask:0xf bank_mask:0xf
    v_mfma_f32_16x16x32_bf16 v[28:31], v[16:19], v[108:111], v[28:31]
    s_waitcnt vmcnt(21)
    buffer_load_dwordx4 v[108:111], v1, s[8:11], s16 offen offset:0 nt
    s_xor_b32 s16, s16, s69
    s_cmp_eq_u32 s21, s3
    s_cbranch_scc1 L_pub_v2_0
L_pubx_v2_0:
    global_load_dword v54, v73, s[64:65] sc1
    v_mov_b32_dpp v84, v83 row_ror:4 row_mask:0xf bank_mask:0xf
    v_mov_b32_dpp v85, v83 row_ror:12 row_mask:0xf bank_mask:0xf
    v_mfma_f32_16x16x32_bf16 v[24:27], v[20:23], v[112:115], v[24:27]
    s_waitcnt vmcnt(22)
    buffer_load_dwordx4 v[112:115], v1, s[8:11], s16 offen offset:0 nt
    s_xor_b32 s16, s16, s68
    v_and_b32_dpp v16, v80, v12 quad_perm:[2,2,2,2] row_mask:0xf bank_mask:0xf
    v_and_b32_dpp v17, v80, v13 quad_perm:[2,2,2,2] row_mask:0xf bank_mask:0xf
    v_and_b32_dpp v18, v81, v14 quad_perm:[2,2,2,2] row_mask:0xf bank_mask:0xf
    v_and_b32_dpp v19, v81, v15 quad_perm:[2,2,2,2] row_mask:0xf bank_mask:0xf
    v_mfma_f32_16x16x32_bf16 v[28:31], v[20:23], v[116:119], v[28:31]
    s_waitcnt vmcnt(22)
    buffer_load_dwordx4 v[116:119], v1, s[8:11], s16 offen offset:0 nt
    s_xor_b32 s16, s16, s71
    v_mfma_f32_16x16x32_bf16 v[24:27], v[16:19], v[120:123], v[24:27]
    s_waitcnt vmcnt(22)
    buffer_load_dwordx4 v[120:123], v1, s[8:11], s16 offen offset:0 nt
    s_xor_b32 s16, s16, s68
    s_add_u32 s17, s17, 1
    s_bfe_u32 s12, s17, 0x10000
    s_lshl_b32 s12, s12, 17
    s_xor_b32 s13, s14, s12
    v_and_b32_dpp v20, v82, v12 quad_perm:[2,2,2,2] row_mask:0xf bank_mask:0xf
    v_and_b32_dpp v21, v82, v13 quad_perm:[2,2,2,2] row_mask:0xf bank_mask:0xf
    v_and_b32_dpp v22, v80, v14 quad_perm:[2,2,2,2] row_mask:0xf bank_mask:0xf
    v_and_b32_dpp v23, v80, v15 quad_perm:[2,2,2,2] row_mask:0xf bank_mask:0xf
    v_mfma_f32_16x16x32_bf16 v[28:31], v[16:19], v[124:127], v[28:31]
    s_waitcnt vmcnt(22)
    buffer_load_dwordx4 v[124:127], v1, s[8:11], s16 offen offset:0 nt
    s_xor_b32 s16, s16, s69
    s_bfe_u32 s12, s17, 0x10001
    s_lshl_b32 s12, s12, 9
    s_xor_b32 s13, s13, s12
    v_mfma_f32_16x16x32_bf16 v[24:27], v[20:23], v[128:131], v[24:27]
    s_waitcnt vmcnt(22)
    buffer_load_dwordx4 v[128:131], v1, s[8:11], s16 offen offset:0 nt
    s_xor_b32 s16, s16, s68
    s_bfe_u32 s12, s17, 0x30002
    s_lshl_b32 s12, s12, 18
    s_xor_b32 s13, s13, s12
    v_and_b32_dpp v16, v80, v12 quad_perm:[3,3,3,3] row_mask:0xf bank_mask:0xf
    v_and_b32_dpp v17, v80, v13 quad_perm:[3,3,3,3] row_mask:0xf bank_mask:0xf
    v_and_b32_dpp v18, v81, v14 quad_perm:[3,3,3,3] row_mask:0xf bank_mask:0xf
    v_and_b32_dpp v19, v81, v15 quad_perm:[3,3,3,3] row_mask:0xf bank_mask:0xf
    v_mfma_f32_16x16x32_bf16 v[28:31], v[20:23], v[132:135], v[28:31]
    s_waitcnt vmcnt(22)
    buffer_load_dwordx4 v[132:135], v1, s[8:11], s16 offen offset:0 nt
    s_xor_b32 s16, s16, s70
    v_mfma_f32_16x16x32_bf16 v[24:27], v[16:19], v[136:139], v[24:27]
    s_waitcnt vmcnt(22)
    buffer_load_dwordx4 v[136:139], v1, s[8:11], s16 offen offset:0 nt
    s_xor_b32 s16, s16, s68
    v_and_b32_dpp v20, v82, v12 quad_perm:[3,3,3,3] row_mask:0xf bank_mask:0xf
    v_and_b32_dpp v21, v82, v13 quad_perm:[3,3,3,3] row_mask:0xf bank_mask:0xf
    v_and_b32_dpp v22, v80, v14 quad_perm:[3,3,3,3] row_mask:0xf bank_mask:0xf
    v_and_b32_dpp v23, v80, v15 quad_perm:[3,3,3,3] row_mask:0xf bank_mask:0xf
    v_mfma_f32_16x16x32_bf16 v[28:31], v[16:19], v[140:143], v[28:31]
    s_waitcnt vmcnt(22)
    buffer_load_dwordx4 v[140:143], v1, s[8:11], s16 offen offset:0 nt
    s_xor_b32 s16, s16, s69
    v_mfma_f32_16x16x32_bf16 v[24:27], v[20:23], v[144:147], v[24:27]
    s_waitcnt vmcnt(22)
    buffer_load_dwordx4 v[144:147], v1, s[8:11], s16 offen offset:0 nt
    s_xor_b32 s16, s16, s68
    v_and_b32_dpp v16, v83, v12 quad_perm:[0,0,0,0] row_mask:0xf bank_mask:0xf
    v_and_b32_dpp v17, v83, v13 quad_perm:[0,0,0,0] row_mask:0xf bank_mask:0xf
    v_and_b32_dpp v18, v84, v14 quad_perm:[0,0,0,0] row_mask:0xf bank_mask:0xf
    v_and_b32_dpp v19, v84, v15 quad_perm:[0,0,0,0] row_mask:0xf bank_mask:0xf
    v_mfma_f32_16x16x32_bf16 v[28:31], v[20:23], v[148:151], v[28:31]
    s_waitcnt vmcnt(22)
    buffer_load_dwordx4 v[148:151], v1, s[8:11], s16 offen offset:0 nt
    s_xor_b32 s16, s16, s71
    v_mfma_f32_16x16x32_bf16 v[24:27], v[16:19], v[152:155], v[24:27]
    s_waitcnt vmcnt(22)
    buffer_load_dwordx4 v[152:155], v1, s[8:11], s16 offen offset:1024 nt
    s_xor_b32 s16, s16, s68
    v_and_b32_dpp v20, v85, v12 quad_perm:[0,0,0,0] row_mask:0xf bank_mask:0xf
    v_and_b32_dpp v21, v85, v13 quad_perm:[0,0,0,0] row_mask:0xf bank_mask:0xf
    v_and_b32_dpp v22, v83, v14 quad_perm:[0,0,0,0] row_mask:0xf bank_mask:0xf
    v_and_b32_dpp v23, v83, v15 quad_perm:[0,0,0,0] row_mask:0xf bank_mask:0xf
    v_mfma_f32_16x16x32_bf16 v[28:31], v[16:19], v[156:159], v[28:31]
    s_waitcnt vmcnt(22) lgkmcnt(0)
    buffer_load_dwordx4 v[156:159], v1, s[8:11], s16 offen offset:1024 nt
    s_xor_b32 s16, s16, s69
    v_fma_f32 v7, v48, s18, -v11
    v_exp_f32 v7, v7
    ds_read_b32 v48, v72 offset:768
    v_mfma_f32_16x16x32_bf16 v[24:27], v[20:23], v[160:163], v[24:27]
    s_waitcnt vmcnt(22)
    buffer_load_dwordx4 v[160:163], v1, s[8:11], s16 offen offset:1024 nt
    s_xor_b32 s16, s16, s68
    v_and_b32_dpp v16, v83, v12 quad_perm:[1,1,1,1] row_mask:0xf bank_mask:0xf
    v_and_b32_dpp v17, v83, v13 quad_perm:[1,1,1,1] row_mask:0xf bank_mask:0xf
    v_and_b32_dpp v18, v84, v14 quad_perm:[1,1,1,1] row_mask:0xf bank_mask:0xf
    v_and_b32_dpp v19, v84, v15 quad_perm:[1,1,1,1] row_mask:0xf bank_mask:0xf
    v_mfma_f32_16x16x32_bf16 v[28:31], v[20:23], v[164:167], v[28:31]
    s_waitcnt vmcnt(22)
    buffer_load_dwordx4 v[164:167], v1, s[8:11], s16 offen offset:1024 nt
    s_xor_b32 s16, s16, s70
    v_cvt_pk_bf16_f32 v80, v7, v7
    v_add_f32 v9, v9, v7
    v_mfma_f32_16x16x32_bf16 v[24:27], v[16:19], v[168:171], v[24:27]
    s_waitcnt vmcnt(22)
    buffer_load_dwordx4 v[168:171], v1, s[8:11], s16 offen offset:1024 nt
    s_xor_b32 s16, s16, s68
    v_and_b32_dpp v20, v85, v12 quad_perm:[1,1,1,1] row_mask:0xf bank_mask:0xf
    v_and_b32_dpp v21, v85, v13 quad_perm:[1,1,1,1] row_mask:0xf bank_mask:0xf
    v_and_b32_dpp v22, v83, v14 quad_perm:[1,1,1,1] row_mask:0xf bank_mask:0xf
    v_and_b32_dpp v23, v83, v15 quad_perm:[1,1,1,1] row_mask:0xf bank_mask:0xf
    v_mfma_f32_16x16x32_bf16 v[28:31], v[16:19], v[172:175], v[28:31]
    s_waitcnt vmcnt(22)
    buffer_load_dwordx4 v[172:175], v1, s[8:11], s16 offen offset:1024 nt
    s_xor_b32 s16, s16, s69
    v_mov_b32_dpp v81, v80 row_ror:4 row_mask:0xf bank_mask:0xf
    v_mov_b32_dpp v82, v80 row_ror:12 row_mask:0xf bank_mask:0xf
    v_mfma_f32_16x16x32_bf16 v[24:27], v[20:23], v[176:179], v[24:27]
    s_waitcnt vmcnt(22)
    buffer_load_dwordx4 v[176:179], v1, s[8:11], s16 offen offset:1024 nt
    s_xor_b32 s16, s16, s68
    v_and_b32_dpp v16, v83, v12 quad_perm:[2,2,2,2] row_mask:0xf bank_mask:0xf
    v_and_b32_dpp v17, v83, v13 quad_perm:[2,2,2,2] row_mask:0xf bank_mask:0xf
    v_and_b32_dpp v18, v84, v14 quad_perm:[2,2,2,2] row_mask:0xf bank_mask:0xf
    v_and_b32_dpp v19, v84, v15 quad_perm:[2,2,2,2] row_mask:0xf bank_mask:0xf
    v_mfma_f32_16x16x32_bf16 v[28:31], v[20:23], v[180:183], v[28:31]
    s_waitcnt vmcnt(22)
    buffer_load_dwordx4 v[180:183], v1, s[8:11], s16 offen offset:1024 nt
    s_xor_b32 s16, s16, s71
    v_mfma_f32_16x16x32_bf16 v[24:27], v[16:19], v[184:187], v[24:27]
    s_waitcnt vmcnt(22)
    buffer_load_dwordx4 v[184:187], v1, s[8:11], s16 offen offset:1024 nt
    s_xor_b32 s16, s16, s68
    v_and_b32_dpp v20, v85, v12 quad_perm:[2,2,2,2] row_mask:0xf bank_mask:0xf
    v_and_b32_dpp v21, v85, v13 quad_perm:[2,2,2,2] row_mask:0xf bank_mask:0xf
    v_and_b32_dpp v22, v83, v14 quad_perm:[2,2,2,2] row_mask:0xf bank_mask:0xf
    v_and_b32_dpp v23, v83, v15 quad_perm:[2,2,2,2] row_mask:0xf bank_mask:0xf
    v_mfma_f32_16x16x32_bf16 v[28:31], v[16:19], v[188:191], v[28:31]
    s_waitcnt vmcnt(22)
    buffer_load_dwordx4 v[188:191], v1, s[8:11], s16 offen offset:1024 nt
    s_xor_b32 s16, s16, s69
    s_cmp_eq_u32 s21, s6
    s_cbranch_scc1 L_pub_v2_1
L_pubx_v2_1:
    v_mfma_f32_16x16x32_bf16 v[24:27], v[20:23], v[192:195], v[24:27]
    s_waitcnt vmcnt(22)
    buffer_load_dwordx4 v[192:195], v1, s[8:11], s16 offen offset:1024 nt
    s_xor_b32 s16, s16, s68
    v_and_b32_dpp v16, v83, v12 quad_perm:[3,3,3,3] row_mask:0xf bank_mask:0xf
    v_and_b32_dpp v17, v83, v13 quad_perm:[3,3,3,3] row_mask:0xf bank_mask:0xf
    v_and_b32_dpp v18, v84, v14 quad_perm:[3,3,3,3] row_mask:0xf bank_mask:0xf
    v_and_b32_dpp v19, v84, v15 quad_perm:[3,3,3,3] row_mask:0xf bank_mask:0xf
    v_mfma_f32_16x16x32_bf16 v[28:31], v[20:23], v[196:199], v[28:31]
    s_waitcnt vmcnt(21)
    buffer_load_dwordx4 v[196:199], v1, s[8:11], s16 offen offset:1024 nt
    s_xor_b32 s16, s16, s70
    v_readlane_b32 s42, v74, s21
    s_add_u32 s49, s49, s50
    s_lshr_b32 s22, s49, 4
    s_and_b32 s49, s49, 15
    v_mfma_f32_16x16x32_bf16 v[24:27], v[16:19], v[200:203], v[24:27]
    s_waitcnt vmcnt(21)
    buffer_load_dwordx4 v[200:203], v1, s[8:11], s16 offen offset:1024 nt
    s_xor_b32 s16, s16, s68
    v_and_b32_dpp v20, v85, v12 quad_perm:[3,3,3,3] row_mask:0xf bank_mask:0xf
    v_and_b32_dpp v21, v85, v13 quad_perm:[3,3,3,3] row_mask:0xf bank_mask:0xf
    v_and_b32_dpp v22, v83, v14 quad_perm:[3,3,3,3] row_mask:0xf bank_mask:0xf
    v_and_b32_dpp v23, v83, v15 quad_perm:[3,3,3,3] row_mask:0xf bank_mask:0xf
    v_mfma_f32_16x16x32_bf16 v[28:31], v[16:19], v[204:207], v[28:31]
    s_waitcnt vmcnt(21)
    buffer_load_dwordx4 v[204:207], v1, s[8:11], s16 offen offset:1024 nt
    s_xor_b32 s16, s16, s69
    v_readlane_b32 s23, v54, s21
    v_mfma_f32_16x16x32_bf16 v[24:27], v[20:23], v[208:211], v[24:27]
    s_waitcnt vmcnt(21)
    buffer_load_dwordx4 v[208:211], v1, s[8:11], s16 offen offset:1024 nt
    s_xor_b32 s16, s16, s68
    s_xor_b32 s42, s42, s23
    s_bcnt1_i32_b32 s42, s42
    s_lshr_b32 s42, 0x90100, s42
    s_and_b32 s42, s42, 15
    s_add_u32 s22, s22, s42
    v_and_b32_dpp v16, v80, v12 quad_perm:[0,0,0,0] row_mask:0xf bank_mask:0xf
    v_and_b32_dpp v17, v80, v13 quad_perm:[0,0,0,0] row_mask:0xf bank_mask:0xf
    v_and_b32_dpp v18, v81, v14 quad_perm:[0,0,0,0] row_mask:0xf bank_mask:0xf
    v_and_b32_dpp v19, v81, v15 quad_perm:[0,0,0,0] row_mask:0xf bank_mask:0xf
    v_mfma_f32_16x16x32_bf16 v[28:31], v[20:23], v[212:215], v[28:31]
    s_waitcnt vmcnt(21)
    buffer_load_dwordx4 v[212:215], v1, s[8:11], s16 offen offset:1024 nt
    s_mov_b32 s16, s13
    v_add_u32 v72, 512, v72
    s_add_u32 s21, s21, 1
    s_cmp_eq_u32 s21, s66
    s_cbranch_scc1 L_vev
    s_cmp_eq_u32 s22, 1
    s_cbranch_scc1 L_v1
    s_cmp_eq_u32 s22, 2
    s_cbranch_scc1 L_v2
    s_cmp_eq_u32 s22, 0
    s_cbranch_scc1 L_v0
    s_branch L_v3
L_pub_v2_0:
    s_mov_b64 exec, s[4:5]
    global_store_byte v73, v75, s[64:65]
    s_mov_b64 exec, -1
    s_add_u32 s3, s3, 32
    s_branch L_pubx_v2_0
L_pub_v2_1:
    s_mov_b64 exec, s[4:5]
    global_store_short v73, v75, s[64:65]
    s_mov_b64 exec, -1
    s_add_u32 s6, s6, 32
    s_lshl_b64 s[4:5], s[4:5], 32
    s_branch L_pubx_v2_1
L_v3:
    v_mfma_f32_16x16x32_bf16 v[24:27], v[16:19], v[88:91], v[24:27]
    s_waitcnt vmcnt(23)
    buffer_load_dwordx4 v[88:91], v1, s[8:11], s16 offen offset:0 nt
    s_xor_b32 s16, s16, s68
    v_and_b32_dpp v20, v82, v12 quad_perm:[0,0,0,0] row_mask:0xf bank_mask:0xf
    v_and_b32_dpp v21, v82, v13 quad_perm:[0,0,0,0] row_mask:0xf bank_mask:0xf
    v_and_b32_dpp v22, v80, v14 quad_perm:[0,0,0,0] row_mask:0xf bank_mask:0xf
    v_and_b32_dpp v23, v80, v15 quad_perm:[0,0,0,0] row_mask:0xf bank_mask:0xf
    v_mfma_f32_16x16x32_bf16 v[28:31], v[16:19], v[92:95], v[28:31]
    s_waitcnt vmcnt(23) lgkmcnt(0)
    buffer_load_dwordx4 v[92:95], v1, s[8:11], s16 offen offset:0 nt
    s_xor_b32 s16, s16, s69
    v_fma_f32 v7, v48, s18, -v11
    v_exp_f32 v7, v7
    ds_read_b32 v48, v72 offset:512
    v_mfma_f32_16x16x32_bf16 v[24:27], v[20:23], v[96:99], v[24:27]
    s_waitcnt vmcnt(23)
    buffer_load_dwordx4 v[96:99], v1, s[8:11], s16 offen offset:0 nt
    s_xor_b32 s16, s16, s68
    v_and_b32_dpp v16, v80, v12 quad_perm:[1,1,1,1] row_mask:0xf bank_mask:0xf
    v_and_b32_dpp v17, v80, v13 quad_perm:[1,1,1,1] row_mask:0xf bank_mask:0xf
    v_and_b32_dpp v18, v81, v14 quad_perm:[1,1,1,1] row_mask:0xf bank_mask:0xf
    v_and_b32_dpp v19, v81, v15 quad_perm:[1,1,1,1] row_mask:0xf bank_mask:0xf
    v_mfma_f32_16x16x32_bf16 v[28:31], v[20:23], v[100:103], v[28:31]
    s_waitcnt vmcnt(23)
    buffer_load_dwordx4 v[100:103], v1, s[8:11], s16 offen offset:0 nt
    s_xor_b32 s16, s16, s70
    v_cvt_pk_bf16_f32 v83, v7, v7
    v_add_f32 v9, v9, v7
    v_mfma_f32_16x16x32_bf16 v[24:27], v[16:19], v[104:107], v[24:27]
    s_waitcnt vmcnt(23)
    buffer_load_dwordx4 v[104:107], v1, s[8:11], s16 offen offset:0 nt
    s_xor_b32 s16, s16, s68
    v_and_b32_dpp v20, v82, v12 quad_perm:[1,1,1,1] row_mask:0xf bank_mask:0xf
    v_and_b32_dpp v21, v82, v13 quad_perm:[1,1,1,1] row_mask:0xf bank_mask:0xf
    v_and_b32_dpp v22, v80, v14 quad_perm:[1,1,1,1] row_mask:0xf bank_mask:0xf
    v_and_b32_dpp v23, v80, v15 quad_perm:[1,1,1,1] row_mask:0xf bank_mask:0xf
    v_mfma_f32_16x16x32_bf16 v[28:31], v[16:19], v[108:111], v[28:31]
    s_waitcnt vmcnt(23)
    buffer_load_dwordx4 v[108:111], v1, s[8:11], s16 offen offset:0 nt
    s_xor_b32 s16, s16, s69
    s_cmp_eq_u32 s21, s3
    s_cbranch_scc1 L_pub_v3_0
L_pubx_v3_0:
    global_load_dword v54, v73, s[64:65] sc1
    v_mov_b32_dpp v84, v83 row_ror:4 row_mask:0xf bank_mask:0xf
    v_mov_b32_dpp v85, v83 row_ror:12 row_mask:0xf bank_mask:0xf
    v_mfma_f32_16x16x32_bf16 v[24:27], v[20:23], v[112:115], v[24:27]
    s_waitcnt vmcnt(24)
    buffer_load_dwordx4 v[112:115], v1, s[8:11], s16 offen offset:0 nt
    s_xor_b32 s16, s16, s68
    v_and_b32_dpp v16, v80, v12 quad_perm:[2,2,2,2] row_mask:0xf bank_mask:0xf
    v_and_b32_dpp v17, v80, v13 quad_perm:[2,2,2,2] row_mask:0xf bank_mask:0xf
    v_and_b32_dpp v18, v81, v14 quad_perm:[2,2,2,2] row_mask:0xf bank_mask:0xf
    v_and_b32_dpp v19, v81, v15 quad_perm:[2,2,2,2] row_mask:0xf bank_mask:0xf
    v_mfma_f32_16x16x32_bf16 v[28:31], v[20:23], v[116:119], v[28:31]
    s_waitcnt vmcnt(24)
    buffer_load_dwordx4 v[116:119], v1, s[8:11], s16 offen offset:0 nt
    s_xor_b32 s16, s16, s71
    v_mfma_f32_16x16x32_bf16 v[24:27], v[16:19], v[120:123], v[24:27]
    s_waitcnt vmcnt(24)
    buffer_load_dwordx4 v[120:123], v1, s[8:11], s16 offen offset:0 nt
    s_xor_b32 s16, s16, s68
    s_add_u32 s17, s17, 1
    s_bfe_u32 s12, s17, 0x10000
    s_lshl_b32 s12, s12, 17
    s_xor_b32 s13, s14, s12
    v_and_b32_dpp v20, v82, v12 quad_perm:[2,2,2,2] row_mask:0xf bank_mask:0xf
    v_and_b32_dpp v21, v82, v13 quad_perm:[2,2,2,2] row_mask:0xf bank_mask:0xf
    v_and_b32_dpp v22, v80, v14 quad_perm:[2,2,2,2] row_mask:0xf bank_mask:0xf
    v_and_b32_dpp v23, v80, v15 quad_perm:[2,2,2,2] row_mask:0xf bank_mask:0xf
    v_mfma_f32_16x16x32_bf16 v[28:31], v[16:19], v[124:127], v[28:31]
    s_waitcnt vmcnt(24)
    buffer_load_dwordx4 v[124:127], v1, s[8:11], s16 offen offset:0 nt
    s_xor_b32 s16, s16, s69
    s_bfe_u32 s12, s17, 0x10001
    s_lshl_b32 s12, s12, 9
    s_xor_b32 s13, s13, s12
    v_mfma_f32_16x16x32_bf16 v[24:27], v[20:23], v[128:131], v[24:27]
    s_waitcnt vmcnt(24)
    buffer_load_dwordx4 v[128:131], v1, s[8:11], s16 offen offset:0 nt
    s_xor_b32 s16, s16, s68
    s_bfe_u32 s12, s17, 0x30002
    s_lshl_b32 s12, s12, 18
    s_xor_b32 s13, s13, s12
    v_and_b32_dpp v16, v80, v12 quad_perm:[3,3,3,3] row_mask:0xf bank_mask:0xf
    v_and_b32_dpp v17, v80, v13 quad_perm:[3,3,3,3] row_mask:0xf bank_mask:0xf
    v_and_b32_dpp v18, v81, v14 quad_perm:[3,3,3,3] row_mask:0xf bank_mask:0xf
    v_and_b32_dpp v19, v81, v15 quad_perm:[3,3,3,3] row_mask:0xf bank_mask:0xf
    v_mfma_f32_16x16x32_bf16 v[28:31], v[20:23], v[132:135], v[28:31]
    s_waitcnt vmcnt(24)
    buffer_load_dwordx4 v[132:135], v1, s[8:11], s16 offen offset:0 nt
    s_xor_b32 s16, s16, s70
    v_mfma_f32_16x16x32_bf16 v[24:27], v[16:19], v[136:139], v[24:27]
    s_waitcnt vmcnt(24)
    buffer_load_dwordx4 v[136:139], v1, s[8:11], s16 offen offset:0 nt
    s_xor_b32 s16, s16, s68
    v_and_b32_dpp v20, v82, v12 quad_perm:[3,3,3,3] row_mask:0xf bank_mask:0xf
    v_and_b32_dpp v21, v82, v13 quad_perm:[3,3,3,3] row_mask:0xf bank_mask:0xf
    v_and_b32_dpp v22, v80, v14 quad_perm:[3,3,3,3] row_mask:0xf bank_mask:0xf
    v_and_b32_dpp v23, v80, v15 quad_perm:[3,3,3,3] row_mask:0xf bank_mask:0xf
    v_mfma_f32_16x16x32_bf16 v[28:31], v[16:19], v[140:143], v[28:31]
    s_waitcnt vmcnt(24)
    buffer_load_dwordx4 v[140:143], v1, s[8:11], s16 offen offset:0 nt
    s_xor_b32 s16, s16, s69
    v_mfma_f32_16x16x32_bf16 v[24:27], v[20:23], v[144:147], v[24:27]
    s_waitcnt vmcnt(24)
    buffer_load_dwordx4 v[144:147], v1, s[8:11], s16 offen offset:0 nt
    s_xor_b32 s16, s16, s68
    v_and_b32_dpp v16, v83, v12 quad_perm:[0,0,0,0] row_mask:0xf bank_mask:0xf
    v_and_b32_dpp v17, v83, v13 quad_perm:[0,0,0,0] row_mask:0xf bank_mask:0xf
    v_and_b32_dpp v18, v84, v14 quad_perm:[0,0,0,0] row_mask:0xf bank_mask:0xf
    v_and_b32_dpp v19, v84, v15 quad_perm:[0,0,0,0] row_mask:0xf bank_mask:0xf
    v_mfma_f32_16x16x32_bf16 v[28:31], v[20:23], v[148:151], v[28:31]
    s_waitcnt vmcnt(24)
    buffer_load_dwordx4 v[148:151], v1, s[8:11], s16 offen offset:0 nt
    s_xor_b32 s16, s16, s71
    v_mfma_f32_16x16x32_bf16 v[24:27], v[16:19], v[152:155], v[24:27]
    s_waitcnt vmcnt(24)
    buffer_load_dwordx4 v[152:155], v1, s[8:11], s16 offen offset:1024 nt
    s_xor_b32 s16, s16, s68
    v_and_b32_dpp v20, v85, v12 quad_perm:[0,0,0,0] row_mask:0xf bank_mask:0xf
    v_and_b32_dpp v21, v85, v13 quad_perm:[0,0,0,0] row_mask:0xf bank_mask:0xf
    v_and_b32_dpp v22, v83, v14 quad_perm:[0,0,0,0] row_mask:0xf bank_mask:0xf
    v_and_b32_dpp v23, v83, v15 quad_perm:[0,0,0,0] row_mask:0xf bank_mask:0xf
    v_mfma_f32_16x16x32_bf16 v[28:31], v[16:19], v[156:159], v[28:31]
    s_waitcnt vmcnt(24) lgkmcnt(0)
    buffer_load_dwordx4 v[156:159], v1, s[8:11], s16 offen offset:1024 nt
    s_xor_b32 s16, s16, s69
    v_fma_f32 v7, v48, s18, -v11
    v_exp_f32 v7, v7
    ds_read_b32 v48, v72 offset:768
    v_mfma_f32_16x16x32_bf16 v[24:27], v[20:23], v[160:163], v[24:27]
    s_waitcnt vmcnt(24)
    buffer_load_dwordx4 v[160:163], v1, s[8:11], s16 offen offset:1024 nt
    s_xor_b32 s16, s16, s68
    v_and_b32_dpp v16, v83, v12 quad_perm:[1,1,1,1] row_mask:0xf bank_mask:0xf
    v_and_b32_dpp v17, v83, v13 quad_perm:[1,1,1,1] row_mask:0xf bank_mask:0xf
    v_and_b32_dpp v18, v84, v14 quad_perm:[1,1,1,1] row_mask:0xf bank_mask:0xf
    v_and_b32_dpp v19, v84, v15 quad_perm:[1,1,1,1] row_mask:0xf bank_mask:0xf
    v_mfma_f32_16x16x32_bf16 v[28:31], v[20:23], v[164:167], v[28:31]
    s_waitcnt vmcnt(24)
    buffer_load_dwordx4 v[164:167], v1, s[8:11], s16 offen offset:1024 nt
    s_xor_b32 s16, s16, s70
    v_cvt_pk_bf16_f32 v80, v7, v7
    v_add_f32 v9, v9, v7
    v_mfma_f32_16x16x32_bf16 v[24:27], v[16:19], v[168:171], v[24:27]
    s_waitcnt vmcnt(24)
    buffer_load_dwordx4 v[168:171], v1, s[8:11], s16 offen offset:1024 nt
    s_xor_b32 s16, s16, s68
    v_and_b32_dpp v20, v85, v12 quad_perm:[1,1,1,1] row_mask:0xf bank_mask:0xf
    v_and_b32_dpp v21, v85, v13 quad_perm:[1,1,1,1] row_mask:0xf bank_mask:0xf
    v_and_b32_dpp v22, v83, v14 quad_perm:[1,1,1,1] row_mask:0xf bank_mask:0xf
    v_and_b32_dpp v23, v83, v15 quad_perm:[1,1,1,1] row_mask:0xf bank_mask:0xf
    v_mfma_f32_16x16x32_bf16 v[28:31], v[16:19], v[172:175], v[28:31]
    s_waitcnt vmcnt(24)
    buffer_load_dwordx4 v[172:175], v1, s[8:11], s16 offen offset:1024 nt
    s_xor_b32 s16, s16, s69
    v_mov_b32_dpp v81, v80 row_ror:4 row_mask:0xf bank_mask:0xf
    v_mov_b32_dpp v82, v80 row_ror:12 row_mask:0xf bank_mask:0xf
    v_mfma_f32_16x16x32_bf16 v[24:27], v[20:23], v[176:179], v[24:27]
    s_waitcnt vmcnt(24)
    buffer_load_dwordx4 v[176:179], v1, s[8:11], s16 offen offset:1024 nt
    s_xor_b32 s16, s16, s68
    v_and_b32_dpp v16, v83, v12 quad_perm:[2,2,2,2] row_mask:0xf bank_mask:0xf
    v_and_b32_dpp v17, v83, v13 quad_perm:[2,2,2,2] row_mask:0xf bank_mask:0xf
    v_and_b32_dpp v18, v84, v14 quad_perm:[2,2,2,2] row_mask:0xf bank_mask:0xf
    v_and_b32_dpp v19, v84, v15 quad_perm:[2,2,2,2] row_mask:0xf bank_mask:0xf
    v_mfma_f32_16x16x32_bf16 v[28:31], v[20:23], v[180:183], v[28:31]
    s_waitcnt vmcnt(24)
    buffer_load_dwordx4 v[180:183], v1, s[8:11], s16 offen offset:1024 nt
    s_xor_b32 s16, s16, s71
    v_mfma_f32_16x16x32_bf16 v[24:27], v[16:19], v[184:187], v[24:27]
    s_waitcnt vmcnt(24)
    buffer_load_dwordx4 v[184:187], v1, s[8:11], s16 offen offset:1024 nt
    s_xor_b32 s16, s16, s68
    v_and_b32_dpp v20, v85, v12 quad_perm:[2,2,2,2] row_mask:0xf bank_mask:0xf
    v_and_b32_dpp v21, v85, v13 quad_perm:[2,2,2,2] row_mask:0xf bank_mask:0xf
    v_and_b32_dpp v22, v83, v14 quad_perm:[2,2,2,2] row_mask:0xf bank_mask:0xf
    v_and_b32_dpp v23, v83, v15 quad_perm:[2,2,2,2] row_mask:0xf bank_mask:0xf
    v_mfma_f32_16x16x32_bf16 v[28:31], v[16:19], v[188:191], v[28:31]
    s_waitcnt vmcnt(24)
    buffer_load_dwordx4 v[188:191], v1, s[8:11], s16 offen offset:1024 nt
    s_xor_b32 s16, s16, s69
    s_cmp_eq_u32 s21, s6
    s_cbranch_scc1 L_pub_v3_1
L_pubx_v3_1:
    v_mfma_f32_16x16x32_bf16 v[24:27], v[20:23], v[192:195], v[24:27]
    s_waitcnt vmcnt(24)
    buffer_load_dwordx4 v[192:195], v1, s[8:11], s16 offen offset:1024 nt
    s_xor_b32 s16, s16, s68
    v_and_b32_dpp v16, v83, v12 quad_perm:[3,3,3,3] row_mask:0xf bank_mask:0xf
    v_and_b32_dpp v17, v83, v13 quad_perm:[3,3,3,3] row_mask:0xf bank_mask:0xf
    v_and_b32_dpp v18, v84, v14 quad_perm:[3,3,3,3] row_mask:0xf bank_mask:0xf
    v_and_b32_dpp v19, v84, v15 quad_perm:[3,3,3,3] row_mask:0xf bank_mask:0xf
    v_mfma_f32_16x16x32_bf16 v[28:31], v[20:23], v[196:199], v[28:31]
    s_waitcnt vmcnt(24)
    buffer_load_dwordx4 v[196:199], v1, s[8:11], s16 offen offset:1024 nt
    s_xor_b32 s16, s16, s70
    v_readlane_b32 s42, v74, s21
    s_add_u32 s49, s49, s50
    s_lshr_b32 s22, s49, 4
    s_and_b32 s49, s49, 15
    v_mfma_f32_16x16x32_bf16 v[24:27], v[16:19], v[200:203], v[24:27]
    s_waitcnt vmcnt(24)
    buffer_load_dwordx4 v[200:203], v1, s[8:11], s16 offen offset:1024 nt
    s_xor_b32 s16, s16, s68
    v_and_b32_dpp v20, v85, v12 quad_perm:[3,3,3,3] row_mask:0xf bank_mask:0xf
    v_and_b32_dpp v21, v85, v13 quad_perm:[3,3,3,3] row_mask:0xf bank_mask:0xf
    v_and_b32_dpp v22, v83, v14 quad_perm:[3,3,3,3] row_mask:0xf bank_mask:0xf
    v_and_b32_dpp v23, v83, v15 quad_perm:[3,3,3,3] row_mask:0xf bank_mask:0xf
    v_mfma_f32_16x16x32_bf16 v[28:31], v[16:19], v[204:207], v[28:31]
    s_waitcnt vmcnt(23)
    buffer_load_dwordx4 v[204:207], v1, s[8:11], s16 offen offset:1024 nt
    s_xor_b32 s16, s16, s69
    v_readlane_b32 s23, v54, s21
    v_mfma_f32_16x16x32_bf16 v[24:27], v[20:23], v[208:211], v[24:27]
    s_waitcnt vmcnt(23)
    buffer_load_dwordx4 v[208:211], v1, s[8:11], s16 offen offset:1024 nt
    s_xor_b32 s16, s16, s68
    s_xor_b32 s42, s42, s23
    s_bcnt1_i32_b32 s42, s42
    s_lshr_b32 s42, 0x90100, s42
    s_and_b32 s42, s42, 15
    s_add_u32 s22, s22, s42
    v_and_b32_dpp v16, v80, v12 quad_perm:[0,0,0,0] row_mask:0xf bank_mask:0xf
    v_and_b32_dpp v17, v80, v13 quad_perm:[0,0,0,0] row_mask:0xf bank_mask:0xf
    v_and_b32_dpp v18, v81, v14 quad_perm:[0,0,0,0] row_mask:0xf bank_mask:0xf
    v_and_b32_dpp v19, v81, v15 quad_perm:[0,0,0,0] row_mask:0xf bank_mask:0xf
    v_mfma_f32_16x16x32_bf16 v[28:31], v[20:23], v[212:215], v[28:31]
    s_waitcnt vmcnt(23)
    buffer_load_dwordx4 v[212:215], v1, s[8:11], s16 offen offset:1024 nt
    s_mov_b32 s16, s13
    v_add_u32 v72, 512, v72
    s_add_u32 s21, s21, 1
    s_cmp_eq_u32 s21, s66
    s_cbranch_scc1 L_vev
    s_cmp_eq_u32 s22, 1
    s_cbranch_scc1 L_v1
    s_cmp_eq_u32 s22, 2
    s_cbranch_scc1 L_v2
    s_cmp_eq_u32 s22, 0
    s_cbranch_scc1 L_v0
    s_branch L_v3
L_pub_v3_0:
    s_mov_b64 exec, s[4:5]
    global_store_byte v73, v75, s[64:65]
    s_mov_b64 exec, -1
    s_add_u32 s3, s3, 32
    s_branch L_pubx_v3_0
L_pub_v3_1:
    s_mov_b64 exec, s[4:5]
    global_store_short v73, v75, s[64:65]
    s_mov_b64 exec, -1
    s_add_u32 s6, s6, 32
    s_lshl_b64 s[4:5], s[4:5], 32
    s_branch L_pubx_v3_1
L_vev:
    v_not_b32 v69, v69
    v_not_b32 v71, v71
    v_and_or_b32 v45, v69, 1, v11
    v_mfma_f32_16x16x32_bf16 v[24:27], v[16:19], v[88:91], v[24:27]
    v_and_b32_dpp v20, v82, v12 quad_perm:[0,0,0,0] row_mask:0xf bank_mask:0xf
    v_and_b32_dpp v21, v82, v13 quad_perm:[0,0,0,0] row_mask:0xf bank_mask:0xf
    v_and_b32_dpp v22, v80, v14 quad_perm:[0,0,0,0] row_mask:0xf bank_mask:0xf
    v_and_b32_dpp v23, v80, v15 quad_perm:[0,0,0,0] row_mask:0xf bank_mask:0xf
    s_waitcnt vmcnt(30) lgkmcnt(0)
    v_mfma_f32_16x16x32_bf16 v[28:31], v[16:19], v[92:95], v[28:31]
    v_fma_f32 v7, v48, s18, -v11
    v_exp_f32 v7, v7
    v_mfma_f32_16x16x32_bf16 v[24:27], v[20:23], v[96:99], v[24:27]
    v_and_b32_dpp v16, v80, v12 quad_perm:[1,1,1,1] row_mask:0xf bank_mask:0xf
    v_and_b32_dpp v17, v80, v13 quad_perm:[1,1,1,1] row_mask:0xf bank_mask:0xf
    v_and_b32_dpp v18, v81, v14 quad_perm:[1,1,1,1] row_mask:0xf bank_mask:0xf
    v_and_b32_dpp v19, v81, v15 quad_perm:[1,1,1,1] row_mask:0xf bank_mask:0xf
    v_mfma_f32_16x16x32_bf16 v[28:31], v[20:23], v[100:103], v[28:31]
    v_cvt_pk_bf16_f32 v83, v7, v7
    v_add_f32 v9, v9, v7
    v_mfma_f32_16x16x32_bf16 v[24:27], v[16:19], v[104:107], v[24:27]
    v_and_b32_dpp v20, v82, v12 quad_perm:[1,1,1,1] row_mask:0xf bank_mask:0xf
    v_and_b32_dpp v21, v82, v13 quad_perm:[1,1,1,1] row_mask:0xf bank_mask:0xf
    v_and_b32_dpp v22, v80, v14 quad_perm:[1,1,1,1] row_mask:0xf bank_mask:0xf
    v_and_b32_dpp v23, v80, v15 quad_perm:[1,1,1,1] row_mask:0xf bank_mask:0xf
    v_mfma_f32_16x16x32_bf16 v[28:31], v[16:19], v[108:111], v[28:31]
    v_mov_b32_dpp v84, v83 row_ror:4 row_mask:0xf bank_mask:0xf
    v_mov_b32_dpp v85, v83 row_ror:12 row_mask:0xf bank_mask:0xf
    s_waitcnt vmcnt(25)
    v_mfma_f32_16x16x32_bf16 v[24:27], v[20:23], v[112:115], v[24:27]
    v_add_f32_dpp v9, v9, v9 row_ror:1 row_mask:0xf bank_mask:0xf
    v_and_b32_dpp v16, v80, v12 quad_perm:[2,2,2,2] row_mask:0xf bank_mask:0xf
    v_and_b32_dpp v17, v80, v13 quad_perm:[2,2,2,2] row_mask:0xf bank_mask:0xf
    v_and_b32_dpp v18, v81, v14 quad_perm:[2,2,2,2] row_mask:0xf bank_mask:0xf
    v_and_b32_dpp v19, v81, v15 quad_perm:[2,2,2,2] row_mask:0xf bank_mask:0xf
    s_waitcnt vmcnt(24)
    v_mfma_f32_16x16x32_bf16 v[28:31], v[20:23], v[116:119], v[28:31]
    v_add_f32_dpp v9, v9, v9 row_ror:2 row_mask:0xf bank_mask:0xf
    s_waitcnt vmcnt(23)
    v_mfma_f32_16x16x32_bf16 v[24:27], v[16:19], v[120:123], v[24:27]
    v_add_f32_dpp v9, v9, v9 row_ror:4 row_mask:0xf bank_mask:0xf
    v_and_b32_dpp v20, v82, v12 quad_perm:[2,2,2,2] row_mask:0xf bank_mask:0xf
    v_and_b32_dpp v21, v82, v13 quad_perm:[2,2,2,2] row_mask:0xf bank_mask:0xf
    v_and_b32_dpp v22, v80, v14 quad_perm:[2,2,2,2] row_mask:0xf bank_mask:0xf
    v_and_b32_dpp v23, v80, v15 quad_perm:[2,2,2,2] row_mask:0xf bank_mask:0xf
    s_waitcnt vmcnt(22)
    v_mfma_f32_16x16x32_bf16 v[28:31], v[16:19], v[124:127], v[28:31]
    v_add_f32_dpp v9, v9, v9 row_ror:8 row_mask:0xf bank_mask:0xf
    s_waitcnt vmcnt(21)
    v_mfma_f32_16x16x32_bf16 v[24:27], v[20:23], v[128:131], v[24:27]
    v_mov_b32 v5, v9
    v_and_b32_dpp v16, v80, v12 quad_perm:[3,3,3,3] row_mask:0xf bank_mask:0xf
    v_and_b32_dpp v17, v80, v13 quad_perm:[3,3,3,3] row_mask:0xf bank_mask:0xf
    v_and_b32_dpp v18, v81, v14 quad_perm:[3,3,3,3] row_mask:0xf bank_mask:0xf
    v_and_b32_dpp v19, v81, v15 quad_perm:[3,3,3,3] row_mask:0xf bank_mask:0xf
    s_waitcnt vmcnt(20)
    v_mfma_f32_16x16x32_bf16 v[28:31], v[20:23], v[132:135], v[28:31]
    v_permlane16_swap_b32 v9, v5
    s_waitcnt vmcnt(19)
    v_mfma_f32_16x16x32_bf16 v[24:27], v[16:19], v[136:139], v[24:27]
    v_add_f32 v9, v9, v5
    v_and_b32_dpp v20, v82, v12 quad_perm:[3,3,3,3] row_mask:0xf bank_mask:0xf
    v_and_b32_dpp v21, v82, v13 quad_perm:[3,3,3,3] row_mask:0xf bank_mask:0xf
    v_and_b32_dpp v22, v80, v14 quad_perm:[3,3,3,3] row_mask:0xf bank_mask:0xf
    v_and_b32_dpp v23, v80, v15 quad_perm:[3,3,3,3] row_mask:0xf bank_mask:0xf
    s_waitcnt vmcnt(18)
    v_mfma_f32_16x16x32_bf16 v[28:31], v[16:19], v[140:143], v[28:31]
    v_mov_b32 v5, v9
    s_waitcnt vmcnt(17)
    v_mfma_f32_16x16x32_bf16 v[24:27], v[20:23], v[144:147], v[24:27]
    v_permlane32_swap_b32 v9, v5
    v_and_b32_dpp v16, v83, v12 quad_perm:[0,0,0,0] row_mask:0xf bank_mask:0xf
    v_and_b32_dpp v17, v83, v13 quad_perm:[0,0,0,0] row_mask:0xf bank_mask:0xf
    v_and_b32_dpp v18, v84, v14 quad_perm:[0,0,0,0] row_mask:0xf bank_mask:0xf
    v_and_b32_dpp v19, v84, v15 quad_perm:[0,0,0,0] row_mask:0xf bank_mask:0xf
    s_waitcnt vmcnt(16)
    v_mfma_f32_16x16x32_bf16 v[28:31], v[20:23], v[148:151], v[28:31]
    v_add_f32 v9, v9, v5
    s_waitcnt vmcnt(15)
    v_mfma_f32_16x16x32_bf16 v[24:27], v[16:19], v[152:155], v[24:27]
    v_and_b32 v9, -2, v9
    v_and_or_b32 v47, v71, 1, v9
    v_and_b32_dpp v20, v85, v12 quad_perm:[0,0,0,0] row_mask:0xf bank_mask:0xf
    v_and_b32_dpp v21, v85, v13 quad_perm:[0,0,0,0] row_mask:0xf bank_mask:0xf
    v_and_b32_dpp v22, v83, v14 quad_perm:[0,0,0,0] row_mask:0xf bank_mask:0xf
    v_and_b32_dpp v23, v83, v15 quad_perm:[0,0,0,0] row_mask:0xf bank_mask:0xf
    s_waitcnt vmcnt(14)
    v_mfma_f32_16x16x32_bf16 v[28:31], v[16:19], v[156:159], v[28:31]
    v_and_b32_dpp v136, v83, v12 quad_perm:[2,2,2,2] row_mask:0xf bank_mask:0xf
    v_and_b32_dpp v137, v83, v13 quad_perm:[2,2,2,2] row_mask:0xf bank_mask:0xf
    v_and_b32_dpp v138, v84, v14 quad_perm:[2,2,2,2] row_mask:0xf bank_mask:0xf
    v_and_b32_dpp v139, v84, v15 quad_perm:[2,2,2,2] row_mask:0xf bank_mask:0xf
    s_waitcnt vmcnt(13)
    v_mfma_f32_16x16x32_bf16 v[24:27], v[20:23], v[160:163], v[24:27]
    v_and_b32_dpp v16, v83, v12 quad_perm:[1,1,1,1] row_mask:0xf bank_mask:0xf
    v_and_b32_dpp v17, v83, v13 quad_perm:[1,1,1,1] row_mask:0xf bank_mask:0xf
    v_and_b32_dpp v18, v84, v14 quad_perm:[1,1,1,1] row_mask:0xf bank_mask:0xf
    v_and_b32_dpp v19, v84, v15 quad_perm:[1,1,1,1] row_mask:0xf bank_mask:0xf
    s_waitcnt vmcnt(12)
    v_mfma_f32_16x16x32_bf16 v[28:31], v[20:23], v[164:167], v[28:31]
    v_and_b32_dpp v140, v85, v12 quad_perm:[2,2,2,2] row_mask:0xf bank_mask:0xf
    v_and_b32_dpp v141, v85, v13 quad_perm:[2,2,2,2] row_mask:0xf bank_mask:0xf
    v_and_b32_dpp v142, v83, v14 quad_perm:[2,2,2,2] row_mask:0xf bank_mask:0xf
    v_and_b32_dpp v143, v83, v15 quad_perm:[2,2,2,2] row_mask:0xf bank_mask:0xf
    s_waitcnt vmcnt(11)
    v_mfma_f32_16x16x32_bf16 v[24:27], v[16:19], v[168:171], v[24:27]
    v_and_b32_dpp v20, v85, v12 quad_perm:[1,1,1,1] row_mask:0xf bank_mask:0xf
    v_and_b32_dpp v21, v85, v13 quad_perm:[1,1,1,1] row_mask:0xf bank_mask:0xf
    v_and_b32_dpp v22, v83, v14 quad_perm:[1,1,1,1] row_mask:0xf bank_mask:0xf
    v_and_b32_dpp v23, v83, v15 quad_perm:[1,1,1,1] row_mask:0xf bank_mask:0xf
    s_waitcnt vmcnt(10)
    v_mfma_f32_16x16x32_bf16 v[28:31], v[16:19], v[172:175], v[28:31]
    v_and_b32_dpp v144, v83, v12 quad_perm:[3,3,3,3] row_mask:0xf bank_mask:0xf
    v_and_b32_dpp v145, v83, v13 quad_perm:[3,3,3,3] row_mask:0xf bank_mask:0xf
    v_and_b32_dpp v146, v84, v14 quad_perm:[3,3,3,3] row_mask:0xf bank_mask:0xf
    v_and_b32_dpp v147, v84, v15 quad_perm:[3,3,3,3] row_mask:0xf bank_mask:0xf
    s_waitcnt vmcnt(9)
    v_mfma_f32_16x16x32_bf16 v[24:27], v[20:23], v[176:179], v[24:27]
    s_waitcnt vmcnt(8)
    v_mfma_f32_16x16x32_bf16 v[28:31], v[20:23], v[180:183], v[28:31]
    v_and_b32_dpp v148, v85, v12 quad_perm:[3,3,3,3] row_mask:0xf bank_mask:0xf
    v_and_b32_dpp v149, v85, v13 quad_perm:[3,3,3,3] row_mask:0xf bank_mask:0xf
    v_and_b32_dpp v150, v83, v14 quad_perm:[3,3,3,3] row_mask:0xf bank_mask:0xf
    v_and_b32_dpp v151, v83, v15 quad_perm:[3,3,3,3] row_mask:0xf bank_mask:0xf
    s_waitcnt vmcnt(7)
    v_mfma_f32_16x16x32_bf16 v[24:27], v[136:139], v[184:187], v[24:27]
    s_waitcnt vmcnt(6)
    v_mfma_f32_16x16x32_bf16 v[28:31], v[136:139], v[188:191], v[28:31]
    s_waitcnt vmcnt(5)
    v_mfma_f32_16x16x32_bf16 v[24:27], v[140:143], v[192:195], v[24:27]
    s_waitcnt vmcnt(4)
    v_mfma_f32_16x16x32_bf16 v[28:31], v[140:143], v[196:199], v[28:31]
    global_load_dwordx4 v[32:35], v3, s[40:41] sc1
    global_load_dwordx4 v[36:39], v50, s[40:41] sc1
    global_load_dwordx4 v[40:43], v51, s[40:41] sc1
    s_waitcnt vmcnt(6)
    v_mfma_f32_16x16x32_bf16 v[24:27], v[144:147], v[200:203], v[24:27]
    s_waitcnt vmcnt(5)
    v_mfma_f32_16x16x32_bf16 v[28:31], v[144:147], v[204:207], v[28:31]
    s_waitcnt vmcnt(4)
    v_mfma_f32_16x16x32_bf16 v[24:27], v[148:151], v[208:211], v[24:27]
    s_waitcnt vmcnt(3)
    v_mfma_f32_16x16x32_bf16 v[28:31], v[148:151], v[212:215], v[28:31]
    global_load_dwordx4 v[120:123], v3, s[40:41] sc1
    global_load_dwordx4 v[124:127], v50, s[40:41] sc1
    global_load_dwordx4 v[128:131], v51, s[40:41] sc1
    s_mov_b32 s21, 12
    s_nop 1
    v_permlane32_swap_b32 v24, v26
    v_permlane32_swap_b32 v25, v27
    v_permlane32_swap_b32 v28, v30
    v_permlane32_swap_b32 v29, v31
    s_nop 0
    v_add_f32 v44, v24, v30
    v_add_f32 v46, v25, v31
    global_store_dwordx4 v52, v[44:47], s[40:41]
    s_waitcnt vmcnt(4)
    v_bitop3_b32 v5, 1, v33, v57 bitop3:0x60
    v_bitop3_b32 v5, v5, v35, v59 bitop3:0x60
    v_bitop3_b32 v5, v5, v37, v61 bitop3:0x60
    v_bitop3_b32 v5, v5, v39, v63 bitop3:0x60
    v_bitop3_b32 v5, v5, v41, v65 bitop3:0x60
    v_bitop3_b32 v5, v5, v43, v67 bitop3:0x60
    v_cmp_eq_u32 vcc, 0, v5
    s_cbranch_vccz L_fin
    global_load_dwordx4 v[32:35], v3, s[40:41] sc1
    global_load_dwordx4 v[36:39], v50, s[40:41] sc1
    global_load_dwordx4 v[40:43], v51, s[40:41] sc1
    s_waitcnt vmcnt(4)
L_poll:
    v_bitop3_b32 v5, 1, v121, v57 bitop3:0x60
    v_bitop3_b32 v5, v5, v123, v59 bitop3:0x60
    v_bitop3_b32 v5, v5, v125, v61 bitop3:0x60
    v_bitop3_b32 v5, v5, v127, v63 bitop3:0x60
    v_bitop3_b32 v5, v5, v129, v65 bitop3:0x60
    v_bitop3_b32 v5, v5, v131, v67 bitop3:0x60
    v_cmp_eq_u32 vcc, 0, v5
    s_cbranch_vccz L_finb
    global_load_dwordx4 v[120:123], v3, s[40:41] sc1
    global_load_dwordx4 v[124:127], v50, s[40:41] sc1
    global_load_dwordx4 v[128:131], v51, s[40:41] sc1
    s_waitcnt vmcnt(3)
    v_bitop3_b32 v5, 1, v33, v57 bitop3:0x60
    v_bitop3_b32 v5, v5, v35, v59 bitop3:0x60
    v_bitop3_b32 v5, v5, v37, v61 bitop3:0x60
    v_bitop3_b32 v5, v5, v39, v63 bitop3:0x60
    v_bitop3_b32 v5, v5, v41, v65 bitop3:0x60
    v_bitop3_b32 v5, v5, v43, v67 bitop3:0x60
    v_cmp_eq_u32 vcc, 0, v5
    s_cbranch_vccz L_fin
    global_load_dwordx4 v[32:35], v3, s[40:41] sc1
    global_load_dwordx4 v[36:39], v50, s[40:41] sc1
    global_load_dwordx4 v[40:43], v51, s[40:41] sc1
    s_sub_u32 s21, s21, 1
    s_waitcnt vmcnt(3)
    s_cbranch_scc0 L_poll
    s_add_u32 s40, s40, 0x80000
    s_addc_u32 s41, s41, 0
    global_store_dwordx4 v52, v[44:47], s[40:41] sc1
    s_lshl_b32 s42, s19, 2
    v_mov_b32 v54, s42
    v_mov_b32 v55, 1
    s_mov_b64 exec, 1
    s_waitcnt vmcnt(0)
    global_atomic_add v5, v54, v55, s[38:39] sc0
    s_waitcnt vmcnt(0)
    v_readfirstlane_b32 s42, v5
    s_mov_b64 exec, -1
    s_cmp_lg_u32 s42, 3
    s_cbranch_scc1 L_end
    global_load_dwordx4 v[32:35], v3, s[40:41] sc1
    global_load_dwordx4 v[36:39], v50, s[40:41] sc1
    global_load_dwordx4 v[40:43], v51, s[40:41] sc1
    s_waitcnt vmcnt(0)
L_fin:
    v_and_b32 v33, -2, v33
    v_and_b32 v37, -2, v37
    v_and_b32 v41, -2, v41
    v_max3_f32 v10, v11, v33, v37
    v_max_f32 v10, v10, v41
    v_sub_f32 v24, v11, v10
    v_sub_f32 v25, v33, v10
    v_sub_f32 v26, v37, v10
    v_sub_f32 v27, v41, v10
    v_exp_f32 v24, v24
    v_exp_f32 v25, v25
    v_exp_f32 v26, v26
    v_exp_f32 v27, v27
    v_and_b32 v47, -2, v47
    v_and_b32 v35, -2, v35
    v_and_b32 v39, -2, v39
    v_and_b32 v43, -2, v43
    v_pk_mul_f32 v[88:89], v[46:47], v[24:25] op_sel_hi:[1,0]
    v_pk_mul_f32 v[90:91], v[34:35], v[24:25] op_sel:[0,1] op_sel_hi:[1,1]
    v_pk_mul_f32 v[92:93], v[38:39], v[26:27] op_sel_hi:[1,0]
    v_pk_mul_f32 v[94:95], v[42:43], v[26:27] op_sel:[0,1] op_sel_hi:[1,1]
    v_pk_add_f32 v[88:89], v[88:89], v[90:91]
    v_pk_add_f32 v[92:93], v[92:93], v[94:95]
    v_pk_add_f32 v[88:89], v[88:89], v[92:93]
    v_rcp_f32 v9, v89
    v_mul_f32 v96, v24, v44
    v_mul_f32 v97, v25, v32
    v_mul_f32 v98, v26, v36
    v_mul_f32 v99, v27, v40
    v_add_f32 v96, v96, v97
    v_add_f32 v98, v98, v99
    v_mul_f32 v88, v88, v9
    v_add_f32 v96, v96, v98
    v_mul_f32 v96, v96, v9
    v_cvt_pk_bf16_f32 v88, v96, v88
    global_store_dword v53, v88, s[36:37]
    s_endpgm
L_finb:
    v_and_b32 v121, -2, v121
    v_and_b32 v125, -2, v125
    v_and_b32 v129, -2, v129
    v_max3_f32 v10, v11, v121, v125
    v_max_f32 v10, v10, v129
    v_sub_f32 v24, v11, v10
    v_sub_f32 v25, v121, v10
    v_sub_f32 v26, v125, v10
    v_sub_f32 v27, v129, v10
    v_exp_f32 v24, v24
    v_exp_f32 v25, v25
    v_exp_f32 v26, v26
    v_exp_f32 v27, v27
    v_and_b32 v47, -2, v47
    v_and_b32 v123, -2, v123
    v_and_b32 v127, -2, v127
    v_and_b32 v131, -2, v131
    v_pk_mul_f32 v[88:89], v[46:47], v[24:25] op_sel_hi:[1,0]
    v_pk_mul_f32 v[90:91], v[122:123], v[24:25] op_sel:[0,1] op_sel_hi:[1,1]
    v_pk_mul_f32 v[92:93], v[126:127], v[26:27] op_sel_hi:[1,0]
    v_pk_mul_f32 v[94:95], v[130:131], v[26:27] op_sel:[0,1] op_sel_hi:[1,1]
    v_pk_add_f32 v[88:89], v[88:89], v[90:91]
    v_pk_add_f32 v[92:93], v[92:93], v[94:95]
    v_pk_add_f32 v[88:89], v[88:89], v[92:93]
    v_rcp_f32 v9, v89
    v_mul_f32 v96, v24, v44
    v_mul_f32 v97, v25, v120
    v_mul_f32 v98, v26, v124
    v_mul_f32 v99, v27, v128
    v_add_f32 v96, v96, v97
    v_add_f32 v98, v98, v99
    v_mul_f32 v88, v88, v9
    v_add_f32 v96, v96, v98
    v_mul_f32 v96, v96, v9
    v_cvt_pk_bf16_f32 v88, v96, v88
    global_store_dword v53, v88, s[36:37]
    s_endpgm
L_end:
    s_endpgm
L_tail:
    .fill (16512 - (L_tail - L_pc)) / 4, 4, 0xbf810000
.section .rodata,"a"
.p2align 6
.amdhsa_kernel standalone__tree_speculative_verify_tree_attention_over_candidate_token_tree__decode_kernel
  .amdhsa_next_free_vgpr 216
  .amdhsa_next_free_sgpr 76
  .amdhsa_accum_offset 216
  .amdhsa_group_segment_fixed_size 0
  .amdhsa_kernarg_size 72
  .amdhsa_user_sgpr_count 2
  .amdhsa_user_sgpr_kernarg_segment_ptr 1
  .amdhsa_system_sgpr_workgroup_id_x 1
  .amdhsa_float_denorm_mode_32 3
.end_amdhsa_kernel
```
